```python
import torch

def _softmax(x, axis=-1):
    return torch.softmax(x, dim=axis)
def _gelu(x):
    return torch.nn.functional.gelu(x, approximate="tanh")
def _silu(x):
    return torch.nn.functional.silu(x)
def _sigmoid(x):
    return torch.sigmoid(x)
def _layernorm(x, axis=-1, eps=1e-5):
    m = x.mean(dim=axis, keepdim=True)
    v = x.var(dim=axis, keepdim=True, unbiased=False)
    return (x - m) / torch.sqrt(v + eps)
def _scatter_add(tgt, idx, src, axis=0):
    return tgt.clone().index_add_(axis, idx, src)
def _segment_sum(src, seg, n):
    out = torch.zeros((n,) + src.shape[1:], dtype=src.dtype)
    return out.index_add_(0, seg, src)
def _pad(x, pw):
    flat = tuple(v for pair in reversed(pw) for v in pair)
    return torch.nn.functional.pad(x, flat)

kernel_name = 'interleave_layers__spectral_fnet__dense_activation_relu__prompt'

def setup_inputs():

    _w = (lambda a: (lambda t: t.to(torch.bfloat16) if t.is_floating_point() else t)(torch.as_tensor(a)))
    def _A_setup():
        B, S, D = 1, 2048, 512
        ns = torch.arange(S)[:, None] * torch.arange(S)[None, :]
        nd = torch.arange(D)[:, None] * torch.arange(D)[None, :]
        Ws_re = torch.cos(-2.0 * torch.pi * ns / S).to(float)
        Ws_im = torch.sin(-2.0 * torch.pi * ns / S).to(float)
        Wd_re = torch.cos(-2.0 * torch.pi * nd / D).to(float)
        Wd_im = torch.sin(-2.0 * torch.pi * nd / D).to(float)
        return {
            "x": _w((lambda *s: torch.randn(*s, dtype=torch.bfloat16) * 0.05)(B, S, D)),
            "dft_seq_re": _w(Ws_re),
            "dft_seq_im": _w(Ws_im),
            "dft_hid_re": _w(Wd_re),
            "dft_hid_im": _w(Wd_im),
        }
    _A_in = _A_setup()

    def _B_setup():
        B, S, D, Dff = 1, 2048, 512, 1792
        return {
            "x": _w((lambda *s: torch.randn(*s, dtype=torch.bfloat16) * 0.05)(B, S, D)),
            "w1": _w((lambda *s: torch.randn(*s, dtype=torch.bfloat16) * 1.6)(D, Dff)),
            "w2": _w((lambda *s: torch.randn(*s, dtype=torch.bfloat16) * 1.6)(Dff, D)),
        }
    _B_in = _B_setup()

    return {
        "A_x": _A_in["x"],
        "A_dft_seq_re": _A_in["dft_seq_re"],
        "A_dft_seq_im": _A_in["dft_seq_im"],
        "A_dft_hid_re": _A_in["dft_hid_re"],
        "A_dft_hid_im": _A_in["dft_hid_im"],
        "B_x": _B_in["x"],
        "B_w1": _B_in["w1"],
        "B_w2": _B_in["w2"],
    }

def reference(A_x, A_dft_seq_re, A_dft_seq_im, A_dft_hid_re, A_dft_hid_im, B_x, B_w1, B_w2):
    def _A_ref(x, dft_seq_re, dft_seq_im, dft_hid_re, dft_hid_im):
        a = torch.einsum("bsd,ed->bse", x, dft_hid_re)
        b = torch.einsum("bsd,ed->bse", x, dft_hid_im)
        y = torch.einsum("ts,bse->bte", dft_seq_re, a) - torch.einsum("ts,bse->bte", dft_seq_im, b)
        return y

    def _B_ref(x, w1, w2):
        h = torch.einsum("bsd,df->bsf", x, w1)
        zero = torch.zeros_like(h)
        h = torch.maximum(h, zero)
        return torch.einsum("bsf,fd->bsd", h, w2)

    x = A_x
    x = x + _A_ref(_layernorm(x, axis=-1), A_dft_seq_re, A_dft_seq_im, A_dft_hid_re, A_dft_hid_im)
    x = x + _B_ref(_layernorm(x, axis=-1), B_w1, B_w2)
    x = x + _A_ref(_layernorm(x, axis=-1), A_dft_seq_re, A_dft_seq_im, A_dft_hid_re, A_dft_hid_im)
    x = x + _B_ref(_layernorm(x, axis=-1), B_w1, B_w2)
    return x
```

```asm
; @launch grid=(256,1,1) block=(256,1,1) lds=163840
.amdgcn_target "amdgcn-amd-amdhsa--gfx950"
.text
.globl interleave_layers__spectral_fnet__dense_activation_relu__prompt_kernel
.p2align 8
.type interleave_layers__spectral_fnet__dense_activation_relu__prompt_kernel,@function
interleave_layers__spectral_fnet__dense_activation_relu__prompt_kernel:
    s_cmp_ge_u32 s2, 256
    s_cbranch_scc1 L_END
    s_load_dwordx2 s[8:9], s[0:1], 0
    s_load_dwordx2 s[12:13], s[0:1], 24
    s_load_dwordx2 s[16:17], s[0:1], 32
    s_load_dwordx2 s[20:21], s[0:1], 48
    s_load_dwordx2 s[24:25], s[0:1], 56
    s_load_dwordx2 s[28:29], s[0:1], 64
    s_load_dwordx2 s[36:37], s[0:1], 72
    s_load_dwordx2 s[32:33], s[0:1], 80
    s_mov_b32 s10, 2097152
    s_mov_b32 s11, 0x00020000
    s_mov_b32 s14, 524288
    s_mov_b32 s15, 0x00020000
    s_mov_b32 s18, 524288
    s_mov_b32 s19, 0x00020000
    s_mov_b32 s22, 1835008
    s_mov_b32 s23, 0x00020000
    s_mov_b32 s26, 1835008
    s_mov_b32 s27, 0x00020000
    s_mov_b32 s30, 2097152
    s_mov_b32 s31, 0x00020000
    s_mov_b32 s38, 256
    s_mov_b32 s39, 0x00020000
    s_mov_b32 s34, 268435456
    s_mov_b32 s35, 0x00020000
    v_lshrrev_b32 v4, 6, v0
    v_and_b32 v0, 63, v0
    v_readfirstlane_b32 s40, v4
    v_and_b32 v1, 31, v0
    v_lshrrev_b32 v2, 5, v0
    v_lshlrev_b32 v3, 4, v0
    s_and_b32 s57, s2, 7
    s_lshl_b32 s57, s57, 1
    s_bfe_u32 s58, s2, 0x10003
    s_add_u32 s43, s57, s58
    s_lshr_b32 s44, s2, 4
    s_and_b32 s42, s44, 7
    s_sub_u32 s57, 32, s43
    s_cmp_eq_u32 s43, 0
    s_cselect_b32 s57, 16, s57
    s_cmp_ge_u32 s44, 8
    s_cselect_b32 s41, s57, s43
    s_mov_b32 s48, s41
    s_sub_u32 s58, 64, s41
    s_cmp_eq_u32 s41, 0
    s_cselect_b32 s49, 32, s58
    s_cmp_ge_u32 s40, 2
    s_cselect_b32 s50, s49, s48
    s_cselect_b32 s57, s57, s43
    s_sub_u32 s58, 64, s57
    s_cmp_eq_u32 s57, 0
    s_cselect_b32 s58, 32, s58
    s_bitcmp1_b32 s40, 0
    s_cselect_b32 s51, s58, s57
    s_getreg_b32 s47, hwreg(HW_REG_XCC_ID, 0, 4)
    s_mov_b32 s56, 0x3f803f80
    s_mov_b32 s46, 0
    s_waitcnt lgkmcnt(0)
    v_mov_b32 v4, 0
    buffer_load_dword v104, v4, s[32:35], 0 offen sc1
    s_lshr_b32 s57, s40, 1
    s_lshl_b32 s57, s57, 5
    s_add_u32 s57, s57, s41
    s_and_b32 s58, s40, 1
    s_lshl_b32 s58, s58, 10
    s_add_u32 s57, s57, s58
    s_lshl_b32 s3, s57, 10
    s_mul_i32 s6, s40, 16640
    s_add_u32 m0, s6, 0
    s_add_u32 s1, s3, 0
    buffer_load_dwordx4 v3, s[8:11], s1 offen lds
    s_add_u32 m0, s6, 1040
    s_add_u32 s1, s3, 65536
    buffer_load_dwordx4 v3, s[8:11], s1 offen lds
    s_add_u32 m0, s6, 2080
    s_add_u32 s1, s3, 131072
    buffer_load_dwordx4 v3, s[8:11], s1 offen lds
    s_add_u32 m0, s6, 3120
    s_add_u32 s1, s3, 196608
    buffer_load_dwordx4 v3, s[8:11], s1 offen lds
    s_add_u32 m0, s6, 4160
    s_add_u32 s1, s3, 262144
    buffer_load_dwordx4 v3, s[8:11], s1 offen lds
    s_add_u32 m0, s6, 5200
    s_add_u32 s1, s3, 327680
    buffer_load_dwordx4 v3, s[8:11], s1 offen lds
    s_add_u32 m0, s6, 6240
    s_add_u32 s1, s3, 393216
    buffer_load_dwordx4 v3, s[8:11], s1 offen lds
    s_add_u32 m0, s6, 7280
    s_add_u32 s1, s3, 458752
    buffer_load_dwordx4 v3, s[8:11], s1 offen lds
    s_lshl_b32 s57, s42, 5
    v_add_u32 v112, s57, v1
    v_cmp_eq_u32 vcc, 0, v112
    v_mov_b32 v113, 0x100
    v_cndmask_b32 v112, v112, v113, vcc
    v_cvt_f32_u32 v112, v112
    v_mul_f32 v112, 0xbb000000, v112
    s_bitcmp1_b32 s40, 0
    s_cselect_b32 s58, 0x3f800000, 0xbf800000
    s_cselect_b64 s[64:65], -1, 0
    v_mul_f32 v113, 1.0, v112
    v_fract_f32 v113, v113
    v_cos_f32 v116, v113
    v_sin_f32 v115, v113
    s_nop 0
    v_mov_b32 v117, v116
    v_mul_f32 v118, s58, v115
    v_sub_f32 v119, 0, v118
    v_mul_f32 v113, 2.0, v112
    v_fract_f32 v113, v113
    v_cos_f32 v120, v113
    v_sin_f32 v115, v113
    s_nop 0
    v_mov_b32 v121, v120
    v_mul_f32 v122, s58, v115
    v_sub_f32 v123, 0, v122
    v_mul_f32 v113, 3.0, v112
    v_fract_f32 v113, v113
    v_cos_f32 v124, v113
    v_sin_f32 v115, v113
    s_nop 0
    v_mov_b32 v125, v124
    v_mul_f32 v126, s58, v115
    v_sub_f32 v127, 0, v126
    v_mul_f32 v113, 0x41000000, v112
    v_fract_f32 v113, v113
    v_cos_f32 v128, v113
    v_sin_f32 v115, v113
    s_nop 0
    v_mov_b32 v129, v128
    v_mul_f32 v130, s58, v115
    v_sub_f32 v131, 0, v130
    s_lshl_b32 s57, s40, 7
    v_lshl_add_u32 v113, v2, 2, s57
    v_cvt_f32_u32 v113, v113
    v_mul_f32 v113, v113, v112
    v_fract_f32 v113, v113
    v_cos_f32 v114, v113
    v_sin_f32 v115, v113
    s_nop 0
    v_cndmask_b32 v132, v114, v115, s[64:65]
    v_cndmask_b32 v133, v115, v114, s[64:65]
    v_pk_mul_f32 v[142:143], v[132:133], v[116:117]
    v_pk_mul_f32 v[144:145], v[132:133], v[120:121]
    v_pk_mul_f32 v[146:147], v[132:133], v[124:125]
    v_pk_mul_f32 v[134:135], v[132:133], v[128:129]
    v_pk_fma_f32 v[136:137], v[132:133], v[118:119], v[142:143] op_sel:[1,0,0] op_sel_hi:[0,1,1]
    v_pk_fma_f32 v[138:139], v[132:133], v[122:123], v[144:145] op_sel:[1,0,0] op_sel_hi:[0,1,1]
    v_pk_fma_f32 v[140:141], v[132:133], v[126:127], v[146:147] op_sel:[1,0,0] op_sel_hi:[0,1,1]
    v_cvt_pk_bf16_f32 v40, v132, v136
    v_cvt_pk_bf16_f32 v41, v138, v140
    s_add_u32 m0, s6, 8320
    s_add_u32 s1, s3, 524288
    buffer_load_dwordx4 v3, s[8:11], s1 offen lds
    v_cvt_pk_bf16_f32 v72, v133, v137
    v_cvt_pk_bf16_f32 v73, v139, v141
    s_add_u32 m0, s6, 9360
    s_add_u32 s1, s3, 589824
    buffer_load_dwordx4 v3, s[8:11], s1 offen lds
    v_pk_fma_f32 v[132:133], v[132:133], v[130:131], v[134:135] op_sel:[1,0,0] op_sel_hi:[0,1,1]
    v_pk_mul_f32 v[142:143], v[132:133], v[116:117]
    v_pk_mul_f32 v[144:145], v[132:133], v[120:121]
    v_pk_mul_f32 v[146:147], v[132:133], v[124:125]
    v_pk_mul_f32 v[134:135], v[132:133], v[128:129]
    v_pk_fma_f32 v[136:137], v[132:133], v[118:119], v[142:143] op_sel:[1,0,0] op_sel_hi:[0,1,1]
    v_pk_fma_f32 v[138:139], v[132:133], v[122:123], v[144:145] op_sel:[1,0,0] op_sel_hi:[0,1,1]
    v_pk_fma_f32 v[140:141], v[132:133], v[126:127], v[146:147] op_sel:[1,0,0] op_sel_hi:[0,1,1]
    v_cvt_pk_bf16_f32 v42, v132, v136
    v_cvt_pk_bf16_f32 v43, v138, v140
    s_add_u32 m0, s6, 10400
    s_add_u32 s1, s3, 655360
    buffer_load_dwordx4 v3, s[8:11], s1 offen lds
    v_cvt_pk_bf16_f32 v74, v133, v137
    v_cvt_pk_bf16_f32 v75, v139, v141
    s_add_u32 m0, s6, 11440
    s_add_u32 s1, s3, 720896
    buffer_load_dwordx4 v3, s[8:11], s1 offen lds
    v_pk_fma_f32 v[132:133], v[132:133], v[130:131], v[134:135] op_sel:[1,0,0] op_sel_hi:[0,1,1]
    v_pk_mul_f32 v[142:143], v[132:133], v[116:117]
    v_pk_mul_f32 v[144:145], v[132:133], v[120:121]
    v_pk_mul_f32 v[146:147], v[132:133], v[124:125]
    v_pk_mul_f32 v[134:135], v[132:133], v[128:129]
    v_pk_fma_f32 v[136:137], v[132:133], v[118:119], v[142:143] op_sel:[1,0,0] op_sel_hi:[0,1,1]
    v_pk_fma_f32 v[138:139], v[132:133], v[122:123], v[144:145] op_sel:[1,0,0] op_sel_hi:[0,1,1]
    v_pk_fma_f32 v[140:141], v[132:133], v[126:127], v[146:147] op_sel:[1,0,0] op_sel_hi:[0,1,1]
    v_cvt_pk_bf16_f32 v44, v132, v136
    v_cvt_pk_bf16_f32 v45, v138, v140
    s_add_u32 m0, s6, 12480
    s_add_u32 s1, s3, 786432
    buffer_load_dwordx4 v3, s[8:11], s1 offen lds
    v_cvt_pk_bf16_f32 v76, v133, v137
    v_cvt_pk_bf16_f32 v77, v139, v141
    s_add_u32 m0, s6, 13520
    s_add_u32 s1, s3, 851968
    buffer_load_dwordx4 v3, s[8:11], s1 offen lds
    v_pk_fma_f32 v[132:133], v[132:133], v[130:131], v[134:135] op_sel:[1,0,0] op_sel_hi:[0,1,1]
    v_pk_mul_f32 v[142:143], v[132:133], v[116:117]
    v_pk_mul_f32 v[144:145], v[132:133], v[120:121]
    v_pk_mul_f32 v[146:147], v[132:133], v[124:125]
    v_pk_mul_f32 v[134:135], v[132:133], v[128:129]
    v_pk_fma_f32 v[136:137], v[132:133], v[118:119], v[142:143] op_sel:[1,0,0] op_sel_hi:[0,1,1]
    v_pk_fma_f32 v[138:139], v[132:133], v[122:123], v[144:145] op_sel:[1,0,0] op_sel_hi:[0,1,1]
    v_pk_fma_f32 v[140:141], v[132:133], v[126:127], v[146:147] op_sel:[1,0,0] op_sel_hi:[0,1,1]
    v_cvt_pk_bf16_f32 v46, v132, v136
    v_cvt_pk_bf16_f32 v47, v138, v140
    s_add_u32 m0, s6, 14560
    s_add_u32 s1, s3, 917504
    buffer_load_dwordx4 v3, s[8:11], s1 offen lds
    v_cvt_pk_bf16_f32 v78, v133, v137
    v_cvt_pk_bf16_f32 v79, v139, v141
    s_add_u32 m0, s6, 15600
    s_add_u32 s1, s3, 983040
    buffer_load_dwordx4 v3, s[8:11], s1 offen lds
    v_pk_fma_f32 v[132:133], v[132:133], v[130:131], v[134:135] op_sel:[1,0,0] op_sel_hi:[0,1,1]
    v_pk_mul_f32 v[142:143], v[132:133], v[116:117]
    v_pk_mul_f32 v[144:145], v[132:133], v[120:121]
    v_pk_mul_f32 v[146:147], v[132:133], v[124:125]
    v_pk_mul_f32 v[134:135], v[132:133], v[128:129]
    v_pk_fma_f32 v[136:137], v[132:133], v[118:119], v[142:143] op_sel:[1,0,0] op_sel_hi:[0,1,1]
    v_pk_fma_f32 v[138:139], v[132:133], v[122:123], v[144:145] op_sel:[1,0,0] op_sel_hi:[0,1,1]
    v_pk_fma_f32 v[140:141], v[132:133], v[126:127], v[146:147] op_sel:[1,0,0] op_sel_hi:[0,1,1]
    v_cvt_pk_bf16_f32 v48, v132, v136
    v_cvt_pk_bf16_f32 v49, v138, v140
    v_cvt_pk_bf16_f32 v80, v133, v137
    v_cvt_pk_bf16_f32 v81, v139, v141
    v_pk_fma_f32 v[132:133], v[132:133], v[130:131], v[134:135] op_sel:[1,0,0] op_sel_hi:[0,1,1]
    v_pk_mul_f32 v[142:143], v[132:133], v[116:117]
    v_pk_mul_f32 v[144:145], v[132:133], v[120:121]
    v_pk_mul_f32 v[146:147], v[132:133], v[124:125]
    v_pk_mul_f32 v[134:135], v[132:133], v[128:129]
    v_pk_fma_f32 v[136:137], v[132:133], v[118:119], v[142:143] op_sel:[1,0,0] op_sel_hi:[0,1,1]
    v_pk_fma_f32 v[138:139], v[132:133], v[122:123], v[144:145] op_sel:[1,0,0] op_sel_hi:[0,1,1]
    v_pk_fma_f32 v[140:141], v[132:133], v[126:127], v[146:147] op_sel:[1,0,0] op_sel_hi:[0,1,1]
    v_cvt_pk_bf16_f32 v50, v132, v136
    v_cvt_pk_bf16_f32 v51, v138, v140
    v_cvt_pk_bf16_f32 v82, v133, v137
    v_cvt_pk_bf16_f32 v83, v139, v141
    v_pk_fma_f32 v[132:133], v[132:133], v[130:131], v[134:135] op_sel:[1,0,0] op_sel_hi:[0,1,1]
    v_pk_mul_f32 v[142:143], v[132:133], v[116:117]
    v_pk_mul_f32 v[144:145], v[132:133], v[120:121]
    v_pk_mul_f32 v[146:147], v[132:133], v[124:125]
    v_pk_mul_f32 v[134:135], v[132:133], v[128:129]
    v_pk_fma_f32 v[136:137], v[132:133], v[118:119], v[142:143] op_sel:[1,0,0] op_sel_hi:[0,1,1]
    v_pk_fma_f32 v[138:139], v[132:133], v[122:123], v[144:145] op_sel:[1,0,0] op_sel_hi:[0,1,1]
    v_pk_fma_f32 v[140:141], v[132:133], v[126:127], v[146:147] op_sel:[1,0,0] op_sel_hi:[0,1,1]
    v_cvt_pk_bf16_f32 v52, v132, v136
    v_cvt_pk_bf16_f32 v53, v138, v140
    v_cvt_pk_bf16_f32 v84, v133, v137
    v_cvt_pk_bf16_f32 v85, v139, v141
    v_pk_fma_f32 v[132:133], v[132:133], v[130:131], v[134:135] op_sel:[1,0,0] op_sel_hi:[0,1,1]
    v_pk_mul_f32 v[142:143], v[132:133], v[116:117]
    v_pk_mul_f32 v[144:145], v[132:133], v[120:121]
    v_pk_mul_f32 v[146:147], v[132:133], v[124:125]
    v_pk_mul_f32 v[134:135], v[132:133], v[128:129]
    v_pk_fma_f32 v[136:137], v[132:133], v[118:119], v[142:143] op_sel:[1,0,0] op_sel_hi:[0,1,1]
    v_pk_fma_f32 v[138:139], v[132:133], v[122:123], v[144:145] op_sel:[1,0,0] op_sel_hi:[0,1,1]
    v_pk_fma_f32 v[140:141], v[132:133], v[126:127], v[146:147] op_sel:[1,0,0] op_sel_hi:[0,1,1]
    v_cvt_pk_bf16_f32 v54, v132, v136
    v_cvt_pk_bf16_f32 v55, v138, v140
    v_cvt_pk_bf16_f32 v86, v133, v137
    v_cvt_pk_bf16_f32 v87, v139, v141
    v_pk_fma_f32 v[132:133], v[132:133], v[130:131], v[134:135] op_sel:[1,0,0] op_sel_hi:[0,1,1]
    v_pk_mul_f32 v[142:143], v[132:133], v[116:117]
    v_pk_mul_f32 v[144:145], v[132:133], v[120:121]
    v_pk_mul_f32 v[146:147], v[132:133], v[124:125]
    v_pk_mul_f32 v[134:135], v[132:133], v[128:129]
    v_pk_fma_f32 v[136:137], v[132:133], v[118:119], v[142:143] op_sel:[1,0,0] op_sel_hi:[0,1,1]
    v_pk_fma_f32 v[138:139], v[132:133], v[122:123], v[144:145] op_sel:[1,0,0] op_sel_hi:[0,1,1]
    v_pk_fma_f32 v[140:141], v[132:133], v[126:127], v[146:147] op_sel:[1,0,0] op_sel_hi:[0,1,1]
    v_cvt_pk_bf16_f32 v56, v132, v136
    v_cvt_pk_bf16_f32 v57, v138, v140
    v_cvt_pk_bf16_f32 v88, v133, v137
    v_cvt_pk_bf16_f32 v89, v139, v141
    v_pk_fma_f32 v[132:133], v[132:133], v[130:131], v[134:135] op_sel:[1,0,0] op_sel_hi:[0,1,1]
    v_pk_mul_f32 v[142:143], v[132:133], v[116:117]
    v_pk_mul_f32 v[144:145], v[132:133], v[120:121]
    v_pk_mul_f32 v[146:147], v[132:133], v[124:125]
    v_pk_mul_f32 v[134:135], v[132:133], v[128:129]
    v_pk_fma_f32 v[136:137], v[132:133], v[118:119], v[142:143] op_sel:[1,0,0] op_sel_hi:[0,1,1]
    v_pk_fma_f32 v[138:139], v[132:133], v[122:123], v[144:145] op_sel:[1,0,0] op_sel_hi:[0,1,1]
    v_pk_fma_f32 v[140:141], v[132:133], v[126:127], v[146:147] op_sel:[1,0,0] op_sel_hi:[0,1,1]
    v_cvt_pk_bf16_f32 v58, v132, v136
    v_cvt_pk_bf16_f32 v59, v138, v140
    v_cvt_pk_bf16_f32 v90, v133, v137
    v_cvt_pk_bf16_f32 v91, v139, v141
    v_pk_fma_f32 v[132:133], v[132:133], v[130:131], v[134:135] op_sel:[1,0,0] op_sel_hi:[0,1,1]
    v_pk_mul_f32 v[142:143], v[132:133], v[116:117]
    v_pk_mul_f32 v[144:145], v[132:133], v[120:121]
    v_pk_mul_f32 v[146:147], v[132:133], v[124:125]
    v_pk_mul_f32 v[134:135], v[132:133], v[128:129]
    v_pk_fma_f32 v[136:137], v[132:133], v[118:119], v[142:143] op_sel:[1,0,0] op_sel_hi:[0,1,1]
    v_pk_fma_f32 v[138:139], v[132:133], v[122:123], v[144:145] op_sel:[1,0,0] op_sel_hi:[0,1,1]
    v_pk_fma_f32 v[140:141], v[132:133], v[126:127], v[146:147] op_sel:[1,0,0] op_sel_hi:[0,1,1]
    v_cvt_pk_bf16_f32 v60, v132, v136
    v_cvt_pk_bf16_f32 v61, v138, v140
    v_cvt_pk_bf16_f32 v92, v133, v137
    v_cvt_pk_bf16_f32 v93, v139, v141
    v_pk_fma_f32 v[132:133], v[132:133], v[130:131], v[134:135] op_sel:[1,0,0] op_sel_hi:[0,1,1]
    v_pk_mul_f32 v[142:143], v[132:133], v[116:117]
    v_pk_mul_f32 v[144:145], v[132:133], v[120:121]
    v_pk_mul_f32 v[146:147], v[132:133], v[124:125]
    v_pk_mul_f32 v[134:135], v[132:133], v[128:129]
    v_pk_fma_f32 v[136:137], v[132:133], v[118:119], v[142:143] op_sel:[1,0,0] op_sel_hi:[0,1,1]
    v_pk_fma_f32 v[138:139], v[132:133], v[122:123], v[144:145] op_sel:[1,0,0] op_sel_hi:[0,1,1]
    v_pk_fma_f32 v[140:141], v[132:133], v[126:127], v[146:147] op_sel:[1,0,0] op_sel_hi:[0,1,1]
    v_cvt_pk_bf16_f32 v62, v132, v136
    v_cvt_pk_bf16_f32 v63, v138, v140
    v_cvt_pk_bf16_f32 v94, v133, v137
    v_cvt_pk_bf16_f32 v95, v139, v141
    v_pk_fma_f32 v[132:133], v[132:133], v[130:131], v[134:135] op_sel:[1,0,0] op_sel_hi:[0,1,1]
    v_pk_mul_f32 v[142:143], v[132:133], v[116:117]
    v_pk_mul_f32 v[144:145], v[132:133], v[120:121]
    v_pk_mul_f32 v[146:147], v[132:133], v[124:125]
    v_pk_mul_f32 v[134:135], v[132:133], v[128:129]
    v_pk_fma_f32 v[136:137], v[132:133], v[118:119], v[142:143] op_sel:[1,0,0] op_sel_hi:[0,1,1]
    v_pk_fma_f32 v[138:139], v[132:133], v[122:123], v[144:145] op_sel:[1,0,0] op_sel_hi:[0,1,1]
    v_pk_fma_f32 v[140:141], v[132:133], v[126:127], v[146:147] op_sel:[1,0,0] op_sel_hi:[0,1,1]
    v_cvt_pk_bf16_f32 v64, v132, v136
    v_cvt_pk_bf16_f32 v65, v138, v140
    v_cvt_pk_bf16_f32 v96, v133, v137
    v_cvt_pk_bf16_f32 v97, v139, v141
    v_pk_fma_f32 v[132:133], v[132:133], v[130:131], v[134:135] op_sel:[1,0,0] op_sel_hi:[0,1,1]
    v_pk_mul_f32 v[142:143], v[132:133], v[116:117]
    v_pk_mul_f32 v[144:145], v[132:133], v[120:121]
    v_pk_mul_f32 v[146:147], v[132:133], v[124:125]
    v_pk_mul_f32 v[134:135], v[132:133], v[128:129]
    v_pk_fma_f32 v[136:137], v[132:133], v[118:119], v[142:143] op_sel:[1,0,0] op_sel_hi:[0,1,1]
    v_pk_fma_f32 v[138:139], v[132:133], v[122:123], v[144:145] op_sel:[1,0,0] op_sel_hi:[0,1,1]
    v_pk_fma_f32 v[140:141], v[132:133], v[126:127], v[146:147] op_sel:[1,0,0] op_sel_hi:[0,1,1]
    v_cvt_pk_bf16_f32 v66, v132, v136
    v_cvt_pk_bf16_f32 v67, v138, v140
    v_cvt_pk_bf16_f32 v98, v133, v137
    v_cvt_pk_bf16_f32 v99, v139, v141
    v_pk_fma_f32 v[132:133], v[132:133], v[130:131], v[134:135] op_sel:[1,0,0] op_sel_hi:[0,1,1]
    v_pk_mul_f32 v[142:143], v[132:133], v[116:117]
    v_pk_mul_f32 v[144:145], v[132:133], v[120:121]
    v_pk_mul_f32 v[146:147], v[132:133], v[124:125]
    v_pk_mul_f32 v[134:135], v[132:133], v[128:129]
    v_pk_fma_f32 v[136:137], v[132:133], v[118:119], v[142:143] op_sel:[1,0,0] op_sel_hi:[0,1,1]
    v_pk_fma_f32 v[138:139], v[132:133], v[122:123], v[144:145] op_sel:[1,0,0] op_sel_hi:[0,1,1]
    v_pk_fma_f32 v[140:141], v[132:133], v[126:127], v[146:147] op_sel:[1,0,0] op_sel_hi:[0,1,1]
    v_cvt_pk_bf16_f32 v68, v132, v136
    v_cvt_pk_bf16_f32 v69, v138, v140
    v_cvt_pk_bf16_f32 v100, v133, v137
    v_cvt_pk_bf16_f32 v101, v139, v141
    v_pk_fma_f32 v[132:133], v[132:133], v[130:131], v[134:135] op_sel:[1,0,0] op_sel_hi:[0,1,1]
    v_pk_mul_f32 v[142:143], v[132:133], v[116:117]
    v_pk_mul_f32 v[144:145], v[132:133], v[120:121]
    v_pk_mul_f32 v[146:147], v[132:133], v[124:125]
    v_pk_fma_f32 v[136:137], v[132:133], v[118:119], v[142:143] op_sel:[1,0,0] op_sel_hi:[0,1,1]
    v_pk_fma_f32 v[138:139], v[132:133], v[122:123], v[144:145] op_sel:[1,0,0] op_sel_hi:[0,1,1]
    v_pk_fma_f32 v[140:141], v[132:133], v[126:127], v[146:147] op_sel:[1,0,0] op_sel_hi:[0,1,1]
    v_cvt_pk_bf16_f32 v70, v132, v136
    v_cvt_pk_bf16_f32 v71, v138, v140
    v_cvt_pk_bf16_f32 v102, v133, v137
    v_cvt_pk_bf16_f32 v103, v139, v141
    v_lshlrev_b32 v4, 12, v2
    s_mul_i32 s57, s41, 7
    s_add_u32 s57, s57, s40
    s_add_u32 s57, s57, 0
    s_lshl_b32 s58, s42, 5
    v_add_u32 v5, s58, v1
    v_mov_b32 v6, 0x200
    v_sub_u32 v6, v6, v5
    v_cmp_eq_u32 vcc, 0, v5
    v_mov_b32 v7, 0x100
    v_cndmask_b32 v6, v6, v7, vcc
    s_bitcmp1_b32 s57, 0
    s_cselect_b64 vcc, -1, 0
    v_cndmask_b32 v5, v5, v6, vcc
    v_lshl_add_u32 v8, v5, 1, v4
    s_lshr_b32 s58, s57, 1
    s_lshl_b32 s58, s58, 14
    s_add_u32 s59, s58, 0
    buffer_load_ushort v240, v8, s[24:27], s59 offen
    s_add_u32 s59, s58, 1024
    buffer_load_ushort v241, v8, s[24:27], s59 offen
    s_add_u32 s59, s58, 2048
    buffer_load_ushort v242, v8, s[24:27], s59 offen
    s_add_u32 s59, s58, 3072
    buffer_load_ushort v243, v8, s[24:27], s59 offen
    s_add_u32 s59, s58, 8192
    buffer_load_ushort v244, v8, s[24:27], s59 offen
    s_add_u32 s59, s58, 9216
    buffer_load_ushort v245, v8, s[24:27], s59 offen
    s_add_u32 s59, s58, 10240
    buffer_load_ushort v246, v8, s[24:27], s59 offen
    s_add_u32 s59, s58, 11264
    buffer_load_ushort v247, v8, s[24:27], s59 offen
WS_1:
    s_cmp_eq_u32 s40, 3
    s_cbranch_scc1 WS_2
    s_mul_i32 s57, s41, 7
    s_add_u32 s57, s57, s40
    s_add_u32 s57, s57, 4
    s_lshl_b32 s58, s42, 5
    v_add_u32 v5, s58, v1
    v_mov_b32 v6, 0x200
    v_sub_u32 v6, v6, v5
    v_cmp_eq_u32 vcc, 0, v5
    v_mov_b32 v7, 0x100
    v_cndmask_b32 v6, v6, v7, vcc
    s_bitcmp1_b32 s57, 0
    s_cselect_b64 vcc, -1, 0
    v_cndmask_b32 v5, v5, v6, vcc
    v_lshl_add_u32 v8, v5, 1, v4
    s_lshr_b32 s58, s57, 1
    s_lshl_b32 s58, s58, 14
    s_add_u32 s59, s58, 0
    buffer_load_ushort v248, v8, s[24:27], s59 offen
    s_add_u32 s59, s58, 1024
    buffer_load_ushort v249, v8, s[24:27], s59 offen
    s_add_u32 s59, s58, 2048
    buffer_load_ushort v250, v8, s[24:27], s59 offen
    s_add_u32 s59, s58, 3072
    buffer_load_ushort v251, v8, s[24:27], s59 offen
    s_add_u32 s59, s58, 8192
    buffer_load_ushort v252, v8, s[24:27], s59 offen
    s_add_u32 s59, s58, 9216
    buffer_load_ushort v253, v8, s[24:27], s59 offen
    s_add_u32 s59, s58, 10240
    buffer_load_ushort v254, v8, s[24:27], s59 offen
    s_add_u32 s59, s58, 11264
    buffer_load_ushort v255, v8, s[24:27], s59 offen
WS_2:
    s_lshr_b32 s57, s40, 1
    v_lshrrev_b32 v7, 1, v1
    s_lshl_b32 s58, s57, 4
    v_add_u32 v7, s58, v7
    v_lshlrev_b32 v8, 6, v7
    s_xor_b32 s59, s57, 0
    s_lshl_b32 s60, s59, 5
    s_add_u32 s60, s60, s41
    v_lshlrev_b32 v9, 8, v2
    v_add_u32 v9, s60, v9
    v_mul_u32_u24 v9, v9, v7
    v_and_b32 v10, 1, v1
    v_lshl_add_u32 v9, v10, 9, v9
    v_cmp_eq_u32 vcc, 1, v1
    s_cmp_eq_u32 s57, 0
    s_cselect_b64 s[64:65], -1, 0
    s_and_b64 vcc, vcc, s[64:65]
    s_lshl_b32 s60, s59, 10
    v_mov_b32 v10, s60
    v_cndmask_b32 v9, v9, v10, vcc
    v_mad_u32_u24 v10, v8, 0, v9
    v_and_b32 v10, 2047, v10
    v_cvt_f32_u32 v10, v10
    v_mul_f32 v10, 0x3a000000, v10
    v_cos_f32 v11, v10
    v_mad_u32_u24 v10, v8, 1, v9
    v_and_b32 v10, 2047, v10
    v_cvt_f32_u32 v10, v10
    v_mul_f32 v10, 0x3a000000, v10
    v_cos_f32 v12, v10
    s_nop 0
    v_cvt_pk_bf16_f32 v24, v11, v12
    v_mad_u32_u24 v10, v8, 2, v9
    v_and_b32 v10, 2047, v10
    v_cvt_f32_u32 v10, v10
    v_mul_f32 v10, 0x3a000000, v10
    v_cos_f32 v11, v10
    v_mad_u32_u24 v10, v8, 3, v9
    v_and_b32 v10, 2047, v10
    v_cvt_f32_u32 v10, v10
    v_mul_f32 v10, 0x3a000000, v10
    v_cos_f32 v12, v10
    s_nop 0
    v_cvt_pk_bf16_f32 v25, v11, v12
    v_mad_u32_u24 v10, v8, 8, v9
    v_and_b32 v10, 2047, v10
    v_cvt_f32_u32 v10, v10
    v_mul_f32 v10, 0x3a000000, v10
    v_cos_f32 v11, v10
    v_mad_u32_u24 v10, v8, 9, v9
    v_and_b32 v10, 2047, v10
    v_cvt_f32_u32 v10, v10
    v_mul_f32 v10, 0x3a000000, v10
    v_cos_f32 v12, v10
    s_nop 0
    v_cvt_pk_bf16_f32 v26, v11, v12
    v_mad_u32_u24 v10, v8, 10, v9
    v_and_b32 v10, 2047, v10
    v_cvt_f32_u32 v10, v10
    v_mul_f32 v10, 0x3a000000, v10
    v_cos_f32 v11, v10
    v_mad_u32_u24 v10, v8, 11, v9
    v_and_b32 v10, 2047, v10
    v_cvt_f32_u32 v10, v10
    v_mul_f32 v10, 0x3a000000, v10
    v_cos_f32 v12, v10
    s_nop 0
    v_cvt_pk_bf16_f32 v27, v11, v12
    v_mad_u32_u24 v10, v8, 16, v9
    v_and_b32 v10, 2047, v10
    v_cvt_f32_u32 v10, v10
    v_mul_f32 v10, 0x3a000000, v10
    v_cos_f32 v11, v10
    v_mad_u32_u24 v10, v8, 17, v9
    v_and_b32 v10, 2047, v10
    v_cvt_f32_u32 v10, v10
    v_mul_f32 v10, 0x3a000000, v10
    v_cos_f32 v12, v10
    s_nop 0
    v_cvt_pk_bf16_f32 v28, v11, v12
    v_mad_u32_u24 v10, v8, 18, v9
    v_and_b32 v10, 2047, v10
    v_cvt_f32_u32 v10, v10
    v_mul_f32 v10, 0x3a000000, v10
    v_cos_f32 v11, v10
    v_mad_u32_u24 v10, v8, 19, v9
    v_and_b32 v10, 2047, v10
    v_cvt_f32_u32 v10, v10
    v_mul_f32 v10, 0x3a000000, v10
    v_cos_f32 v12, v10
    s_nop 0
    v_cvt_pk_bf16_f32 v29, v11, v12
    v_mad_u32_u24 v10, v8, 24, v9
    v_and_b32 v10, 2047, v10
    v_cvt_f32_u32 v10, v10
    v_mul_f32 v10, 0x3a000000, v10
    v_cos_f32 v11, v10
    v_mad_u32_u24 v10, v8, 25, v9
    v_and_b32 v10, 2047, v10
    v_cvt_f32_u32 v10, v10
    v_mul_f32 v10, 0x3a000000, v10
    v_cos_f32 v12, v10
    s_nop 0
    v_cvt_pk_bf16_f32 v30, v11, v12
    v_mad_u32_u24 v10, v8, 26, v9
    v_and_b32 v10, 2047, v10
    v_cvt_f32_u32 v10, v10
    v_mul_f32 v10, 0x3a000000, v10
    v_cos_f32 v11, v10
    v_mad_u32_u24 v10, v8, 27, v9
    v_and_b32 v10, 2047, v10
    v_cvt_f32_u32 v10, v10
    v_mul_f32 v10, 0x3a000000, v10
    v_cos_f32 v12, v10
    s_nop 0
    v_cvt_pk_bf16_f32 v31, v11, v12
    s_xor_b32 s59, s57, 1
    s_lshl_b32 s60, s59, 5
    s_add_u32 s60, s60, s41
    v_lshlrev_b32 v9, 8, v2
    v_add_u32 v9, s60, v9
    v_mul_u32_u24 v9, v9, v7
    v_and_b32 v10, 1, v1
    v_lshl_add_u32 v9, v10, 9, v9
    v_cmp_eq_u32 vcc, 1, v1
    s_cmp_eq_u32 s57, 0
    s_cselect_b64 s[64:65], -1, 0
    s_and_b64 vcc, vcc, s[64:65]
    s_lshl_b32 s60, s59, 10
    v_mov_b32 v10, s60
    v_cndmask_b32 v9, v9, v10, vcc
    v_mad_u32_u24 v10, v8, 0, v9
    v_and_b32 v10, 2047, v10
    v_cvt_f32_u32 v10, v10
    v_mul_f32 v10, 0x3a000000, v10
    v_cos_f32 v11, v10
    v_mad_u32_u24 v10, v8, 1, v9
    v_and_b32 v10, 2047, v10
    v_cvt_f32_u32 v10, v10
    v_mul_f32 v10, 0x3a000000, v10
    v_cos_f32 v12, v10
    s_nop 0
    v_cvt_pk_bf16_f32 v32, v11, v12
    v_mad_u32_u24 v10, v8, 2, v9
    v_and_b32 v10, 2047, v10
    v_cvt_f32_u32 v10, v10
    v_mul_f32 v10, 0x3a000000, v10
    v_cos_f32 v11, v10
    v_mad_u32_u24 v10, v8, 3, v9
    v_and_b32 v10, 2047, v10
    v_cvt_f32_u32 v10, v10
    v_mul_f32 v10, 0x3a000000, v10
    v_cos_f32 v12, v10
    s_nop 0
    v_cvt_pk_bf16_f32 v33, v11, v12
    v_mad_u32_u24 v10, v8, 8, v9
    v_and_b32 v10, 2047, v10
    v_cvt_f32_u32 v10, v10
    v_mul_f32 v10, 0x3a000000, v10
    v_cos_f32 v11, v10
    v_mad_u32_u24 v10, v8, 9, v9
    v_and_b32 v10, 2047, v10
    v_cvt_f32_u32 v10, v10
    v_mul_f32 v10, 0x3a000000, v10
    v_cos_f32 v12, v10
    s_nop 0
    v_cvt_pk_bf16_f32 v34, v11, v12
    v_mad_u32_u24 v10, v8, 10, v9
    v_and_b32 v10, 2047, v10
    v_cvt_f32_u32 v10, v10
    v_mul_f32 v10, 0x3a000000, v10
    v_cos_f32 v11, v10
    v_mad_u32_u24 v10, v8, 11, v9
    v_and_b32 v10, 2047, v10
    v_cvt_f32_u32 v10, v10
    v_mul_f32 v10, 0x3a000000, v10
    v_cos_f32 v12, v10
    s_nop 0
    v_cvt_pk_bf16_f32 v35, v11, v12
    v_mad_u32_u24 v10, v8, 16, v9
    v_and_b32 v10, 2047, v10
    v_cvt_f32_u32 v10, v10
    v_mul_f32 v10, 0x3a000000, v10
    v_cos_f32 v11, v10
    v_mad_u32_u24 v10, v8, 17, v9
    v_and_b32 v10, 2047, v10
    v_cvt_f32_u32 v10, v10
    v_mul_f32 v10, 0x3a000000, v10
    v_cos_f32 v12, v10
    s_nop 0
    v_cvt_pk_bf16_f32 v36, v11, v12
    v_mad_u32_u24 v10, v8, 18, v9
    v_and_b32 v10, 2047, v10
    v_cvt_f32_u32 v10, v10
    v_mul_f32 v10, 0x3a000000, v10
    v_cos_f32 v11, v10
    v_mad_u32_u24 v10, v8, 19, v9
    v_and_b32 v10, 2047, v10
    v_cvt_f32_u32 v10, v10
    v_mul_f32 v10, 0x3a000000, v10
    v_cos_f32 v12, v10
    s_nop 0
    v_cvt_pk_bf16_f32 v37, v11, v12
    v_mad_u32_u24 v10, v8, 24, v9
    v_and_b32 v10, 2047, v10
    v_cvt_f32_u32 v10, v10
    v_mul_f32 v10, 0x3a000000, v10
    v_cos_f32 v11, v10
    v_mad_u32_u24 v10, v8, 25, v9
    v_and_b32 v10, 2047, v10
    v_cvt_f32_u32 v10, v10
    v_mul_f32 v10, 0x3a000000, v10
    v_cos_f32 v12, v10
    s_nop 0
    v_cvt_pk_bf16_f32 v38, v11, v12
    v_mad_u32_u24 v10, v8, 26, v9
    v_and_b32 v10, 2047, v10
    v_cvt_f32_u32 v10, v10
    v_mul_f32 v10, 0x3a000000, v10
    v_cos_f32 v11, v10
    v_mad_u32_u24 v10, v8, 27, v9
    v_and_b32 v10, 2047, v10
    v_cvt_f32_u32 v10, v10
    v_mul_f32 v10, 0x3a000000, v10
    v_cos_f32 v12, v10
    s_nop 0
    v_cvt_pk_bf16_f32 v39, v11, v12
    s_waitcnt vmcnt(24)
    v_readfirstlane_b32 s57, v104
    s_mul_i32 s58, s57, 0x9E3779B1
    s_lshr_b32 s57, s57, 15
    s_xor_b32 s58, s58, s57
    s_add_u32 s58, s58, 0x7F4A7C15
    s_and_b32 s45, s58, 0xfffffff0
    s_waitcnt vmcnt(8)
    s_barrier
    v_mul_u32_u24 v4, 1040, v1
    v_lshl_add_u32 v4, v2, 3, v4
    s_lshl_b32 s57, s40, 8
    v_add_u32 v4, s57, v4
    s_lshr_b32 s57, s40, 1
    s_mul_i32 s58, s57, 33280
    s_xor_b32 s57, s57, 1
    s_mul_i32 s59, s57, 33280
    v_add_u32 v5, s58, v4
    v_add_u32 v6, s59, v4
    ds_read_b64 v[176:177], v5 offset:0
    ds_read_b64 v[178:179], v5 offset:16
    ds_read_b64 v[180:181], v5 offset:32
    ds_read_b64 v[182:183], v5 offset:48
    ds_read_b64 v[184:185], v5 offset:64
    ds_read_b64 v[186:187], v5 offset:80
    ds_read_b64 v[188:189], v5 offset:96
    ds_read_b64 v[190:191], v5 offset:112
    s_waitcnt lgkmcnt(0)
    ds_read_b64 v[192:193], v5 offset:128
    ds_read_b64 v[194:195], v5 offset:144
    ds_read_b64 v[196:197], v5 offset:160
    ds_read_b64 v[198:199], v5 offset:176
    ds_read_b64 v[200:201], v5 offset:192
    ds_read_b64 v[202:203], v5 offset:208
    ds_read_b64 v[204:205], v5 offset:224
    ds_read_b64 v[206:207], v5 offset:240
    s_waitcnt lgkmcnt(0)
    ds_read_b64 v[208:209], v6 offset:0
    ds_read_b64 v[210:211], v6 offset:16
    ds_read_b64 v[212:213], v6 offset:32
    ds_read_b64 v[214:215], v6 offset:48
    ds_read_b64 v[216:217], v6 offset:64
    ds_read_b64 v[218:219], v6 offset:80
    ds_read_b64 v[220:221], v6 offset:96
    ds_read_b64 v[222:223], v6 offset:112
    s_waitcnt lgkmcnt(0)
    ds_read_b64 v[224:225], v6 offset:128
    ds_read_b64 v[226:227], v6 offset:144
    ds_read_b64 v[228:229], v6 offset:160
    ds_read_b64 v[230:231], v6 offset:176
    ds_read_b64 v[232:233], v6 offset:192
    ds_read_b64 v[234:235], v6 offset:208
    ds_read_b64 v[236:237], v6 offset:224
    ds_read_b64 v[238:239], v6 offset:240
    s_waitcnt lgkmcnt(0)
    s_waitcnt vmcnt(0)
    v_lshl_or_b32 v104, v241, 16, v240
    v_lshl_or_b32 v105, v243, 16, v242
    v_lshl_or_b32 v106, v245, 16, v244
    v_lshl_or_b32 v107, v247, 16, v246
    s_mul_i32 s57, s41, 7
    s_add_u32 s57, s57, s40
    s_add_u32 s57, s57, 0
    s_lshl_b32 s57, s57, 10
    s_mul_i32 s58, s42, 229376
    s_add_u32 s57, s57, s58
    s_add_u32 s57, s57, 1048576
    buffer_store_dwordx4 v[104:107], v3, s[32:35], s57 offen sc1
WS_3:
    s_cmp_eq_u32 s40, 3
    s_cbranch_scc1 WS_4
    v_lshl_or_b32 v108, v249, 16, v248
    v_lshl_or_b32 v109, v251, 16, v250
    v_lshl_or_b32 v110, v253, 16, v252
    v_lshl_or_b32 v111, v255, 16, v254
    s_mul_i32 s57, s41, 7
    s_add_u32 s57, s57, s40
    s_add_u32 s57, s57, 4
    s_lshl_b32 s57, s57, 10
    s_mul_i32 s58, s42, 229376
    s_add_u32 s57, s57, s58
    s_add_u32 s57, s57, 1048576
    buffer_store_dwordx4 v[108:111], v3, s[32:35], s57 offen sc1
WS_4:
    s_barrier
    v_lshrrev_b32 v12, 4, v0
    v_and_b32 v13, 15, v0
    v_lshlrev_b32 v14, 2, v12
    v_xor_b32 v13, v13, v14
    v_lshlrev_b32 v13, 4, v13
    v_mul_u32_u24 v12, 3584, v12
    v_add_u32 v15, v12, v13
    s_mul_i32 s70, s40, 458752
    s_lshl_b32 s58, s44, 8
    s_add_u32 s70, s70, s58
    s_lshl_b32 s71, s40, 15
    s_cmp_ge_u32 s44, 14
    s_cselect_b32 s55, 1, 0
    s_cmp_eq_u32 s40, 3
    s_cselect_b32 s63, 1, s55
    s_xor_b32 s57, s40, 0
    s_lshl_b32 s57, s57, 13
    s_add_u32 s57, s57, 131072
    v_add_u32 v4, s57, v3
    s_xor_b32 s57, s40, 2
    s_lshl_b32 s57, s57, 13
    s_add_u32 s57, s57, 131072
    v_add_u32 v5, s57, v3
    s_xor_b32 s57, s40, 3
    s_lshl_b32 s57, s57, 13
    s_add_u32 s57, s57, 131072
    v_add_u32 v6, s57, v3
    v_mov_b32 v8, 0
    v_mov_b32 v9, 0
    v_mov_b32 v10, 0
    v_mov_b32 v11, 0
    s_nop 1
    v_mfma_f32_32x32x16_bf16 v[144:159], v[208:211], v[40:43], 0
    s_cmp_eq_u32 s55, 1
    s_cbranch_scc1 W1C_5
    s_add_u32 m0, s71, 0
    s_add_u32 s58, s70, 0
    buffer_load_dwordx4 v15, s[20:23], s58 offen lds
W1C_5:
    v_dot2_f32_bf16 v10, v208, s56, v10
    v_dot2_f32_bf16 v11, v208, v208, v11
    v_dot2_f32_bf16 v10, v209, s56, v10
    v_dot2_f32_bf16 v11, v209, v209, v11
    v_mfma_f32_32x32x16_bf16 v[160:175], v[208:211], v[72:75], 0
    s_cmp_eq_u32 s55, 1
    s_cbranch_scc1 W1C_6
    s_add_u32 m0, s71, 1024
    s_add_u32 s58, s70, 14336
    buffer_load_dwordx4 v15, s[20:23], s58 offen lds
W1C_6:
    v_dot2_f32_bf16 v10, v210, s56, v10
    v_dot2_f32_bf16 v11, v210, v210, v11
    v_dot2_f32_bf16 v10, v211, s56, v10
    v_dot2_f32_bf16 v11, v211, v211, v11
    v_mfma_f32_32x32x16_bf16 v[144:159], v[212:215], v[44:47], v[144:159]
    s_cmp_eq_u32 s63, 1
    s_cbranch_scc1 W1C_7
    s_add_u32 m0, s71, 2048
    s_add_u32 s58, s70, 28672
    buffer_load_dwordx4 v15, s[20:23], s58 offen lds
W1C_7:
    v_dot2_f32_bf16 v10, v212, s56, v10
    v_dot2_f32_bf16 v11, v212, v212, v11
    v_dot2_f32_bf16 v10, v213, s56, v10
    v_dot2_f32_bf16 v11, v213, v213, v11
    v_mfma_f32_32x32x16_bf16 v[160:175], v[212:215], v[76:79], v[160:175]
    s_cmp_eq_u32 s63, 1
    s_cbranch_scc1 W1C_8
    s_add_u32 m0, s71, 3072
    s_add_u32 s58, s70, 43008
    buffer_load_dwordx4 v15, s[20:23], s58 offen lds
W1C_8:
    v_dot2_f32_bf16 v10, v214, s56, v10
    v_dot2_f32_bf16 v11, v214, v214, v11
    v_dot2_f32_bf16 v10, v215, s56, v10
    v_dot2_f32_bf16 v11, v215, v215, v11
    v_mfma_f32_32x32x16_bf16 v[144:159], v[216:219], v[48:51], v[144:159]
    s_cmp_eq_u32 s63, 1
    s_cbranch_scc1 W1C_9
    s_add_u32 m0, s71, 4096
    s_add_u32 s58, s70, 57344
    buffer_load_dwordx4 v15, s[20:23], s58 offen lds
W1C_9:
    v_dot2_f32_bf16 v10, v216, s56, v10
    v_dot2_f32_bf16 v11, v216, v216, v11
    v_dot2_f32_bf16 v10, v217, s56, v10
    v_dot2_f32_bf16 v11, v217, v217, v11
    v_mfma_f32_32x32x16_bf16 v[160:175], v[216:219], v[80:83], v[160:175]
    s_cmp_eq_u32 s63, 1
    s_cbranch_scc1 W1C_10
    s_add_u32 m0, s71, 5120
    s_add_u32 s58, s70, 71680
    buffer_load_dwordx4 v15, s[20:23], s58 offen lds
W1C_10:
    v_dot2_f32_bf16 v10, v218, s56, v10
    v_dot2_f32_bf16 v11, v218, v218, v11
    v_dot2_f32_bf16 v10, v219, s56, v10
    v_dot2_f32_bf16 v11, v219, v219, v11
    v_mfma_f32_32x32x16_bf16 v[144:159], v[220:223], v[52:55], v[144:159]
    s_cmp_eq_u32 s63, 1
    s_cbranch_scc1 W1C_11
    s_add_u32 m0, s71, 6144
    s_add_u32 s58, s70, 86016
    buffer_load_dwordx4 v15, s[20:23], s58 offen lds
W1C_11:
    v_dot2_f32_bf16 v10, v220, s56, v10
    v_dot2_f32_bf16 v11, v220, v220, v11
    v_dot2_f32_bf16 v10, v221, s56, v10
    v_dot2_f32_bf16 v11, v221, v221, v11
    v_mfma_f32_32x32x16_bf16 v[160:175], v[220:223], v[84:87], v[160:175]
    s_cmp_eq_u32 s55, 1
    s_cbranch_scc1 W1C_12
    s_add_u32 m0, s71, 7168
    s_add_u32 s58, s70, 100352
    buffer_load_dwordx4 v15, s[20:23], s58 offen lds
W1C_12:
    v_dot2_f32_bf16 v10, v222, s56, v10
    v_dot2_f32_bf16 v11, v222, v222, v11
    v_dot2_f32_bf16 v10, v223, s56, v10
    v_dot2_f32_bf16 v11, v223, v223, v11
    v_mfma_f32_32x32x16_bf16 v[144:159], v[224:227], v[56:59], v[144:159]
    s_cmp_eq_u32 s55, 1
    s_cbranch_scc1 W1C_13
    s_add_u32 m0, s71, 8192
    s_add_u32 s58, s70, 114688
    buffer_load_dwordx4 v15, s[20:23], s58 offen lds
W1C_13:
    v_dot2_f32_bf16 v10, v224, s56, v10
    v_dot2_f32_bf16 v11, v224, v224, v11
    v_dot2_f32_bf16 v10, v225, s56, v10
    v_dot2_f32_bf16 v11, v225, v225, v11
    v_mfma_f32_32x32x16_bf16 v[160:175], v[224:227], v[88:91], v[160:175]
    v_dot2_f32_bf16 v10, v226, s56, v10
    v_dot2_f32_bf16 v11, v226, v226, v11
    v_dot2_f32_bf16 v10, v227, s56, v10
    v_dot2_f32_bf16 v11, v227, v227, v11
    v_mfma_f32_32x32x16_bf16 v[144:159], v[228:231], v[60:63], v[144:159]
    s_cmp_eq_u32 s55, 1
    s_cbranch_scc1 W1C_14
    s_add_u32 m0, s71, 9216
    s_add_u32 s58, s70, 129024
    buffer_load_dwordx4 v15, s[20:23], s58 offen lds
W1C_14:
    v_dot2_f32_bf16 v10, v228, s56, v10
    v_dot2_f32_bf16 v11, v228, v228, v11
    v_dot2_f32_bf16 v10, v229, s56, v10
    v_dot2_f32_bf16 v11, v229, v229, v11
    v_mfma_f32_32x32x16_bf16 v[160:175], v[228:231], v[92:95], v[160:175]
    v_dot2_f32_bf16 v10, v230, s56, v10
    v_dot2_f32_bf16 v11, v230, v230, v11
    v_dot2_f32_bf16 v10, v231, s56, v10
    v_dot2_f32_bf16 v11, v231, v231, v11
    v_mfma_f32_32x32x16_bf16 v[144:159], v[232:235], v[64:67], v[144:159]
    s_cmp_eq_u32 s55, 1
    s_cbranch_scc1 W1C_15
    s_add_u32 m0, s71, 10240
    s_add_u32 s58, s70, 143360
    buffer_load_dwordx4 v15, s[20:23], s58 offen lds
W1C_15:
    v_dot2_f32_bf16 v10, v232, s56, v10
    v_dot2_f32_bf16 v11, v232, v232, v11
    v_dot2_f32_bf16 v10, v233, s56, v10
    v_dot2_f32_bf16 v11, v233, v233, v11
    v_mfma_f32_32x32x16_bf16 v[160:175], v[232:235], v[96:99], v[160:175]
    v_dot2_f32_bf16 v10, v234, s56, v10
    v_dot2_f32_bf16 v11, v234, v234, v11
    v_dot2_f32_bf16 v10, v235, s56, v10
    v_dot2_f32_bf16 v11, v235, v235, v11
    v_mfma_f32_32x32x16_bf16 v[144:159], v[236:239], v[68:71], v[144:159]
    s_cmp_eq_u32 s55, 1
    s_cbranch_scc1 W1C_16
    s_add_u32 m0, s71, 11264
    s_add_u32 s58, s70, 157696
    buffer_load_dwordx4 v15, s[20:23], s58 offen lds
W1C_16:
    v_dot2_f32_bf16 v10, v236, s56, v10
    v_dot2_f32_bf16 v11, v236, v236, v11
    v_dot2_f32_bf16 v10, v237, s56, v10
    v_dot2_f32_bf16 v11, v237, v237, v11
    v_mfma_f32_32x32x16_bf16 v[160:175], v[236:239], v[100:103], v[160:175]
    v_dot2_f32_bf16 v10, v238, s56, v10
    v_dot2_f32_bf16 v11, v238, v238, v11
    v_dot2_f32_bf16 v10, v239, s56, v10
    v_dot2_f32_bf16 v11, v239, v239, v11
    v_mfma_f32_32x32x16_bf16 v[112:127], v[176:179], v[40:43], 0
    s_cmp_eq_u32 s55, 1
    s_cbranch_scc1 W1C_17
    s_add_u32 m0, s71, 12288
    s_add_u32 s58, s70, 172032
    buffer_load_dwordx4 v15, s[20:23], s58 offen lds
W1C_17:
    v_dot2_f32_bf16 v8, v176, s56, v8
    v_dot2_f32_bf16 v9, v176, v176, v9
    v_dot2_f32_bf16 v8, v177, s56, v8
    v_dot2_f32_bf16 v9, v177, v177, v9
    v_mfma_f32_32x32x16_bf16 v[128:143], v[176:179], v[72:75], 0
    v_dot2_f32_bf16 v8, v178, s56, v8
    v_dot2_f32_bf16 v9, v178, v178, v9
    v_dot2_f32_bf16 v8, v179, s56, v8
    v_dot2_f32_bf16 v9, v179, v179, v9
    v_mfma_f32_32x32x16_bf16 v[112:127], v[180:183], v[44:47], v[112:127]
    s_cmp_eq_u32 s55, 1
    s_cbranch_scc1 W1C_18
    s_add_u32 m0, s71, 13312
    s_add_u32 s58, s70, 186368
    buffer_load_dwordx4 v15, s[20:23], s58 offen lds
W1C_18:
    v_dot2_f32_bf16 v8, v180, s56, v8
    v_dot2_f32_bf16 v9, v180, v180, v9
    v_dot2_f32_bf16 v8, v181, s56, v8
    v_dot2_f32_bf16 v9, v181, v181, v9
    v_mfma_f32_32x32x16_bf16 v[128:143], v[180:183], v[76:79], v[128:143]
    v_dot2_f32_bf16 v8, v182, s56, v8
    v_dot2_f32_bf16 v9, v182, v182, v9
    v_dot2_f32_bf16 v8, v183, s56, v8
    v_dot2_f32_bf16 v9, v183, v183, v9
    v_mfma_f32_32x32x16_bf16 v[112:127], v[184:187], v[48:51], v[112:127]
    ds_write_b128 v4, v[144:147] offset:0
    s_cmp_eq_u32 s55, 1
    s_cbranch_scc1 W1C_19
    s_add_u32 m0, s71, 14336
    s_add_u32 s58, s70, 200704
    buffer_load_dwordx4 v15, s[20:23], s58 offen lds
W1C_19:
    v_dot2_f32_bf16 v8, v184, s56, v8
    v_dot2_f32_bf16 v9, v184, v184, v9
    v_dot2_f32_bf16 v8, v185, s56, v8
    v_dot2_f32_bf16 v9, v185, v185, v9
    v_mfma_f32_32x32x16_bf16 v[128:143], v[184:187], v[80:83], v[128:143]
    ds_write_b128 v4, v[148:151] offset:1024
    v_dot2_f32_bf16 v8, v186, s56, v8
    v_dot2_f32_bf16 v9, v186, v186, v9
    v_dot2_f32_bf16 v8, v187, s56, v8
    v_dot2_f32_bf16 v9, v187, v187, v9
    v_mfma_f32_32x32x16_bf16 v[112:127], v[188:191], v[52:55], v[112:127]
    ds_write_b128 v4, v[152:155] offset:2048
    s_cmp_eq_u32 s55, 1
    s_cbranch_scc1 W1C_20
    s_add_u32 m0, s71, 15360
    s_add_u32 s58, s70, 215040
    buffer_load_dwordx4 v15, s[20:23], s58 offen lds
W1C_20:
    v_dot2_f32_bf16 v8, v188, s56, v8
    v_dot2_f32_bf16 v9, v188, v188, v9
    v_dot2_f32_bf16 v8, v189, s56, v8
    v_dot2_f32_bf16 v9, v189, v189, v9
    v_mfma_f32_32x32x16_bf16 v[128:143], v[188:191], v[84:87], v[128:143]
    ds_write_b128 v4, v[156:159] offset:3072
    v_dot2_f32_bf16 v8, v190, s56, v8
    v_dot2_f32_bf16 v9, v190, v190, v9
    v_dot2_f32_bf16 v8, v191, s56, v8
    v_dot2_f32_bf16 v9, v191, v191, v9
    v_mfma_f32_32x32x16_bf16 v[112:127], v[192:195], v[56:59], v[112:127]
    ds_write_b128 v4, v[160:163] offset:4096
    s_cmp_eq_u32 s55, 1
    s_cbranch_scc1 W1C_21
    s_add_u32 m0, s71, 16384
    s_add_u32 s58, s70, 229376
    buffer_load_dwordx4 v15, s[20:23], s58 offen lds
W1C_21:
    v_dot2_f32_bf16 v8, v192, s56, v8
    v_dot2_f32_bf16 v9, v192, v192, v9
    v_dot2_f32_bf16 v8, v193, s56, v8
    v_dot2_f32_bf16 v9, v193, v193, v9
    v_mfma_f32_32x32x16_bf16 v[128:143], v[192:195], v[88:91], v[128:143]
    ds_write_b128 v4, v[164:167] offset:5120
    v_dot2_f32_bf16 v8, v194, s56, v8
    v_dot2_f32_bf16 v9, v194, v194, v9
    v_dot2_f32_bf16 v8, v195, s56, v8
    v_dot2_f32_bf16 v9, v195, v195, v9
    v_mfma_f32_32x32x16_bf16 v[112:127], v[196:199], v[60:63], v[112:127]
    ds_write_b128 v4, v[168:171] offset:6144
    s_cmp_eq_u32 s55, 1
    s_cbranch_scc1 W1C_22
    s_add_u32 m0, s71, 17408
    s_add_u32 s58, s70, 243712
    buffer_load_dwordx4 v15, s[20:23], s58 offen lds
W1C_22:
    v_dot2_f32_bf16 v8, v196, s56, v8
    v_dot2_f32_bf16 v9, v196, v196, v9
    v_dot2_f32_bf16 v8, v197, s56, v8
    v_dot2_f32_bf16 v9, v197, v197, v9
    v_mfma_f32_32x32x16_bf16 v[128:143], v[196:199], v[92:95], v[128:143]
    ds_write_b128 v4, v[172:175] offset:7168
    v_dot2_f32_bf16 v8, v198, s56, v8
    v_dot2_f32_bf16 v9, v198, v198, v9
    v_dot2_f32_bf16 v8, v199, s56, v8
    v_dot2_f32_bf16 v9, v199, v199, v9
    v_mfma_f32_32x32x16_bf16 v[112:127], v[200:203], v[64:67], v[112:127]
    s_cmp_eq_u32 s55, 1
    s_cbranch_scc1 W1C_23
    s_add_u32 m0, s71, 18432
    s_add_u32 s58, s70, 258048
    buffer_load_dwordx4 v15, s[20:23], s58 offen lds
W1C_23:
    v_dot2_f32_bf16 v8, v200, s56, v8
    v_dot2_f32_bf16 v9, v200, v200, v9
    v_dot2_f32_bf16 v8, v201, s56, v8
    v_dot2_f32_bf16 v9, v201, v201, v9
    v_mfma_f32_32x32x16_bf16 v[128:143], v[200:203], v[96:99], v[128:143]
    v_dot2_f32_bf16 v8, v202, s56, v8
    v_dot2_f32_bf16 v9, v202, v202, v9
    v_dot2_f32_bf16 v8, v203, s56, v8
    v_dot2_f32_bf16 v9, v203, v203, v9
    v_mfma_f32_32x32x16_bf16 v[112:127], v[204:207], v[68:71], v[112:127]
    s_cmp_eq_u32 s55, 1
    s_cbranch_scc1 W1C_24
    s_add_u32 m0, s71, 19456
    s_add_u32 s58, s70, 272384
    buffer_load_dwordx4 v15, s[20:23], s58 offen lds
W1C_24:
    v_dot2_f32_bf16 v8, v204, s56, v8
    v_dot2_f32_bf16 v9, v204, v204, v9
    v_dot2_f32_bf16 v8, v205, s56, v8
    v_dot2_f32_bf16 v9, v205, v205, v9
    v_mfma_f32_32x32x16_bf16 v[128:143], v[204:207], v[100:103], v[128:143]
    v_dot2_f32_bf16 v8, v206, s56, v8
    v_dot2_f32_bf16 v9, v206, v206, v9
    v_dot2_f32_bf16 v8, v207, s56, v8
    v_dot2_f32_bf16 v9, v207, v207, v9
    v_lshlrev_b32 v12, 6, v1
    v_lshl_add_u32 v12, v2, 3, v12
    s_lshl_b32 s57, s40, 4
    s_add_u32 s57, s57, 100352
    v_add_u32 v12, s57, v12
    s_lshr_b32 s57, s40, 1
    s_lshl_b32 s58, s57, 11
    s_xor_b32 s59, s58, 2048
    v_add_u32 v13, s58, v12
    v_add_u32 v12, s59, v12
    s_nop 1
    ds_write_b64 v13, v[8:9]
    ds_write_b64 v12, v[10:11]
    s_waitcnt lgkmcnt(0)
    s_barrier
    ds_read_b128 v[192:195], v5 offset:4096
    ds_read_b128 v[196:199], v5 offset:5120
    ds_read_b128 v[200:203], v5 offset:6144
    ds_read_b128 v[204:207], v5 offset:7168
    ds_read_b128 v[176:179], v5 offset:0
    ds_read_b128 v[180:183], v5 offset:1024
    ds_read_b128 v[184:187], v5 offset:2048
    ds_read_b128 v[188:191], v5 offset:3072
    s_cmp_eq_u32 s55, 1
    s_cbranch_scc1 W1C_25
    s_add_u32 m0, s71, 20480
    s_add_u32 s58, s70, 286720
    buffer_load_dwordx4 v15, s[20:23], s58 offen lds
W1C_25:
    s_cmp_eq_u32 s55, 1
    s_cbranch_scc1 W1C_26
    s_add_u32 m0, s71, 21504
    s_add_u32 s58, s70, 301056
    buffer_load_dwordx4 v15, s[20:23], s58 offen lds
W1C_26:
    s_cmp_eq_u32 s55, 1
    s_cbranch_scc1 W1C_27
    s_add_u32 m0, s71, 22528
    s_add_u32 s58, s70, 315392
    buffer_load_dwordx4 v15, s[20:23], s58 offen lds
W1C_27:
    s_cmp_eq_u32 s55, 1
    s_cbranch_scc1 W1C_28
    s_add_u32 m0, s71, 23552
    s_add_u32 s58, s70, 329728
    buffer_load_dwordx4 v15, s[20:23], s58 offen lds
W1C_28:
    s_cmp_eq_u32 s55, 1
    s_cbranch_scc1 W1C_29
    s_add_u32 m0, s71, 24576
    s_add_u32 s58, s70, 344064
    buffer_load_dwordx4 v15, s[20:23], s58 offen lds
W1C_29:
    s_cmp_eq_u32 s55, 1
    s_cbranch_scc1 W1C_30
    s_add_u32 m0, s71, 25600
    s_add_u32 s58, s70, 358400
    buffer_load_dwordx4 v15, s[20:23], s58 offen lds
W1C_30:
    s_nop 3
    s_waitcnt lgkmcnt(4)
    v_pk_add_f32 v[128:129], v[128:129], v[192:193]
    v_pk_add_f32 v[130:131], v[130:131], v[194:195]
    v_pk_add_f32 v[132:133], v[132:133], v[196:197]
    v_pk_add_f32 v[134:135], v[134:135], v[198:199]
    v_pk_add_f32 v[136:137], v[136:137], v[200:201]
    v_pk_add_f32 v[138:139], v[138:139], v[202:203]
    v_pk_add_f32 v[140:141], v[140:141], v[204:205]
    v_pk_add_f32 v[142:143], v[142:143], v[206:207]
    s_waitcnt lgkmcnt(0)
    ds_write_b128 v5, v[128:131] offset:0
    ds_write_b128 v5, v[132:135] offset:1024
    ds_write_b128 v5, v[136:139] offset:2048
    ds_write_b128 v5, v[140:143] offset:3072
    v_pk_add_f32 v[112:113], v[112:113], v[176:177]
    v_pk_add_f32 v[114:115], v[114:115], v[178:179]
    v_pk_add_f32 v[116:117], v[116:117], v[180:181]
    v_pk_add_f32 v[118:119], v[118:119], v[182:183]
    v_pk_add_f32 v[120:121], v[120:121], v[184:185]
    v_pk_add_f32 v[122:123], v[122:123], v[186:187]
    v_pk_add_f32 v[124:125], v[124:125], v[188:189]
    v_pk_add_f32 v[126:127], v[126:127], v[190:191]
    s_cmp_eq_u32 s55, 1
    s_cbranch_scc1 W1C_31
    s_add_u32 m0, s71, 26624
    s_add_u32 s58, s70, 372736
    buffer_load_dwordx4 v15, s[20:23], s58 offen lds
W1C_31:
    s_cmp_eq_u32 s55, 1
    s_cbranch_scc1 W1C_32
    s_add_u32 m0, s71, 27648
    s_add_u32 s58, s70, 387072
    buffer_load_dwordx4 v15, s[20:23], s58 offen lds
W1C_32:
    s_cmp_eq_u32 s55, 1
    s_cbranch_scc1 W1C_33
    s_add_u32 m0, s71, 28672
    s_add_u32 s58, s70, 401408
    buffer_load_dwordx4 v15, s[20:23], s58 offen lds
W1C_33:
    s_cmp_eq_u32 s55, 1
    s_cbranch_scc1 W1C_34
    s_add_u32 m0, s71, 29696
    s_add_u32 s58, s70, 415744
    buffer_load_dwordx4 v15, s[20:23], s58 offen lds
W1C_34:
    s_cmp_eq_u32 s55, 1
    s_cbranch_scc1 W1C_35
    s_add_u32 m0, s71, 30720
    s_add_u32 s58, s70, 430080
    buffer_load_dwordx4 v15, s[20:23], s58 offen lds
W1C_35:
    s_cmp_eq_u32 s55, 1
    s_cbranch_scc1 W1C_36
    s_add_u32 m0, s71, 31744
    s_add_u32 s58, s70, 444416
    buffer_load_dwordx4 v15, s[20:23], s58 offen lds
W1C_36:
    s_lshr_b32 s57, s40, 1
    s_lshl_b32 s58, s57, 11
    s_add_u32 s58, s58, 100352
    v_lshlrev_b32 v12, 6, v1
    v_add_u32 v12, s58, v12
    ds_read_b128 v[240:243], v12 offset:0
    ds_read_b128 v[244:247], v12 offset:16
    ds_read_b128 v[248:251], v12 offset:32
    ds_read_b128 v[252:255], v12 offset:48
    s_waitcnt lgkmcnt(0)
    v_pk_add_f32 v[240:241], v[240:241], v[244:245]
    v_pk_add_f32 v[242:243], v[242:243], v[246:247]
    v_pk_add_f32 v[240:241], v[240:241], v[248:249]
    v_pk_add_f32 v[242:243], v[242:243], v[250:251]
    v_pk_add_f32 v[240:241], v[240:241], v[252:253]
    v_pk_add_f32 v[242:243], v[242:243], v[254:255]
    v_pk_add_f32 v[240:241], v[240:241], v[242:243]
    v_mul_f32 v240, 0x3b000000, v240
    v_mul_f32 v241, 0x3b000000, v241
    v_fma_f32 v241, -v240, v240, v241
    v_max_f32 v241, 0, v241
    v_add_f32 v241, 0x3727c5ac, v241
    v_rsq_f32 v241, v241
    s_lshl_b32 s57, s40, 7
    s_add_u32 s57, s57, 104448
    v_lshlrev_b32 v12, 2, v1
    v_add_u32 v12, s57, v12
    v_lshlrev_b32 v13, 4, v2
    v_add_u32 v13, s57, v13
    ds_write_b32 v12, v241
    s_waitcnt lgkmcnt(0)
    ds_read_b128 v[240:243], v13 offset:0
    ds_read_b128 v[244:247], v13 offset:32
    ds_read_b128 v[248:251], v13 offset:64
    ds_read_b128 v[252:255], v13 offset:96
    s_waitcnt lgkmcnt(0)
    s_barrier
    ds_read_b128 v[176:179], v6 offset:0
    ds_read_b128 v[180:183], v6 offset:1024
    ds_read_b128 v[184:187], v6 offset:2048
    ds_read_b128 v[188:191], v6 offset:3072
    s_waitcnt lgkmcnt(3)
    v_pk_add_f32 v[112:113], v[112:113], v[176:177]
    v_pk_add_f32 v[114:115], v[114:115], v[178:179]
    s_waitcnt lgkmcnt(2)
    v_pk_add_f32 v[116:117], v[116:117], v[180:181]
    v_pk_add_f32 v[118:119], v[118:119], v[182:183]
    s_waitcnt lgkmcnt(1)
    v_pk_add_f32 v[120:121], v[120:121], v[184:185]
    v_pk_add_f32 v[122:123], v[122:123], v[186:187]
    s_waitcnt lgkmcnt(0)
    v_pk_add_f32 v[124:125], v[124:125], v[188:189]
    v_pk_add_f32 v[126:127], v[126:127], v[190:191]
    s_cmp_eq_u32 s55, 1
    s_cbranch_scc1 W1R_37
    s_cmp_eq_u32 s40, 3
    s_cbranch_scc0 W1R_37
    s_add_u32 m0, s71, 2048
    s_add_u32 s58, s70, 28672
    buffer_load_dwordx4 v15, s[20:23], s58 offen lds
    s_add_u32 m0, s71, 3072
    s_add_u32 s58, s70, 43008
    buffer_load_dwordx4 v15, s[20:23], s58 offen lds
    s_add_u32 m0, s71, 4096
    s_add_u32 s58, s70, 57344
    buffer_load_dwordx4 v15, s[20:23], s58 offen lds
    s_add_u32 m0, s71, 5120
    s_add_u32 s58, s70, 71680
    buffer_load_dwordx4 v15, s[20:23], s58 offen lds
    s_add_u32 m0, s71, 6144
    s_add_u32 s58, s70, 86016
    buffer_load_dwordx4 v15, s[20:23], s58 offen lds
W1R_37:
    v_pk_mul_f32 v[112:113], v[112:113], v[240:241]
    v_pk_mul_f32 v[114:115], v[114:115], v[242:243]
    v_pk_mul_f32 v[116:117], v[116:117], v[244:245]
    v_pk_mul_f32 v[118:119], v[118:119], v[246:247]
    v_pk_mul_f32 v[120:121], v[120:121], v[248:249]
    v_pk_mul_f32 v[122:123], v[122:123], v[250:251]
    v_pk_mul_f32 v[124:125], v[124:125], v[252:253]
    v_pk_mul_f32 v[126:127], v[126:127], v[254:255]
    v_cvt_pk_bf16_f32 v176, v112, v113
    v_cvt_pk_bf16_f32 v177, v114, v115
    v_cvt_pk_bf16_f32 v178, v116, v117
    v_cvt_pk_bf16_f32 v179, v118, v119
    v_cvt_pk_bf16_f32 v180, v120, v121
    v_cvt_pk_bf16_f32 v181, v122, v123
    v_cvt_pk_bf16_f32 v182, v124, v125
    v_cvt_pk_bf16_f32 v183, v126, v127
    s_lshl_b32 s57, s40, 13
    s_add_u32 s57, s57, 135168
    v_add_u32 v4, s57, v3
    s_xor_b32 s57, s40, 2
    s_lshl_b32 s57, s57, 13
    s_add_u32 s57, s57, 135168
    v_add_u32 v5, s57, v3
    ds_write_b128 v4, v[176:179]
    ds_write_b128 v4, v[180:183] offset:1024
    s_waitcnt lgkmcnt(0)
    s_barrier
    ds_read_b128 v[184:187], v5
    ds_read_b128 v[188:191], v5 offset:1024
    v_mfma_f32_32x32x16_bf16 v[112:127], v[24:27], v[176:179], 0
    v_mfma_f32_32x32x16_bf16 v[112:127], v[28:31], v[180:183], v[112:127]
    v_lshlrev_b32 v4, 17, v2
    v_lshl_add_u32 v4, v1, 2, v4
    s_waitcnt lgkmcnt(0)
    v_mfma_f32_32x32x16_bf16 v[112:127], v[32:35], v[184:187], v[112:127]
    v_mfma_f32_32x32x16_bf16 v[112:127], v[36:39], v[188:191], v[112:127]
    s_lshr_b32 s57, s40, 1
    s_lshl_b32 s57, s57, 20
    s_lshl_b32 s58, s42, 13
    s_add_u32 s57, s57, s58
    s_lshl_b32 s58, s41, 8
    s_add_u32 s57, s57, s58
    s_and_b32 s58, s40, 1
    s_lshl_b32 s58, s58, 7
    s_add_u32 s57, s57, s58
    s_add_u32 s57, s57, 4194304
    s_nop 7
    s_nop 1
    v_cvt_pk_bf16_f32 v176, v112, v113
    v_cvt_pk_bf16_f32 v177, v114, v115
    v_cvt_pk_bf16_f32 v178, v116, v117
    v_cvt_pk_bf16_f32 v179, v118, v119
    v_cvt_pk_bf16_f32 v180, v120, v121
    v_cvt_pk_bf16_f32 v181, v122, v123
    v_cvt_pk_bf16_f32 v182, v124, v125
    v_cvt_pk_bf16_f32 v183, v126, v127
    s_add_u32 s58, s57, 0
    buffer_store_dword v176, v4, s[32:35], s58 offen sc1
    s_add_u32 s58, s57, 65536
    buffer_store_dword v177, v4, s[32:35], s58 offen sc1
    s_add_u32 s58, s57, 262144
    buffer_store_dword v178, v4, s[32:35], s58 offen sc1
    s_add_u32 s58, s57, 327680
    buffer_store_dword v179, v4, s[32:35], s58 offen sc1
    s_add_u32 s58, s57, 524288
    buffer_store_dword v180, v4, s[32:35], s58 offen sc1
    s_add_u32 s58, s57, 589824
    buffer_store_dword v181, v4, s[32:35], s58 offen sc1
    s_add_u32 s58, s57, 786432
    buffer_store_dword v182, v4, s[32:35], s58 offen sc1
    s_add_u32 s58, s57, 851968
    buffer_store_dword v183, v4, s[32:35], s58 offen sc1
    s_cmp_eq_u32 s41, 0
    s_cselect_b32 s57, 1, 2
    s_cselect_b32 s62, 1, 0
    s_cmp_ge_u32 s40, 2
    s_cselect_b32 s57, s57, 0
    s_cselect_b32 s61, 1, 0
    v_lshlrev_b32 v7, 1, v1
    v_add_u32 v7, s57, v7
    s_bitcmp1_b32 s40, 0
    s_cselect_b32 s66, 0xbf800000, 0x3f800000
    s_xor_b32 s60, s66, 0x80000000
    s_and_b32 s59, s62, s61
    s_cmp_eq_u32 s59, 1
    s_cselect_b32 s67, 0, 0x3f800000
    s_cselect_b32 s68, 0x3f800000, 0
    s_cselect_b32 s70, 0, s66
    s_cselect_b32 s63, s66, 0
    s_cmp_eq_u32 s61, 1
    s_cselect_b32 s69, 0xbf800000, 0x3f800000
    s_cselect_b32 s71, s66, s60
    s_cmp_eq_u32 s62, 1
    s_cselect_b32 s69, 0, s69
    s_cselect_b32 s71, 0, s71
    v_lshlrev_b32 v8, 2, v2
    v_add_u32 v8, 0, v8
    v_mul_u32_u24 v8, v8, v7
    v_and_b32 v8, 63, v8
    v_cvt_f32_u32 v8, v8
    v_mul_f32 v8, 0x3c800000, v8
    v_cos_f32 v9, v8
    v_sin_f32 v10, v8
    s_nop 0
    v_mul_f32 v11, s67, v9
    v_mul_f32 v12, s68, v9
    v_fma_f32 v12, s69, v10, v12
    v_cvt_pk_bf16_f32 v11, v11, v12
    v_accvgpr_write_b32 a224, v11
    v_mul_f32 v11, s70, v10
    v_mul_f32 v12, s71, v9
    v_fma_f32 v12, s63, v10, v12
    v_cvt_pk_bf16_f32 v11, v11, v12
    v_accvgpr_write_b32 a240, v11
    v_lshlrev_b32 v8, 2, v2
    v_add_u32 v8, 1, v8
    v_mul_u32_u24 v8, v8, v7
    v_and_b32 v8, 63, v8
    v_cvt_f32_u32 v8, v8
    v_mul_f32 v8, 0x3c800000, v8
    v_cos_f32 v9, v8
    v_sin_f32 v10, v8
    s_nop 0
    v_mul_f32 v11, s67, v9
    v_mul_f32 v12, s68, v9
    v_fma_f32 v12, s69, v10, v12
    v_cvt_pk_bf16_f32 v11, v11, v12
    v_accvgpr_write_b32 a225, v11
    v_mul_f32 v11, s70, v10
    v_mul_f32 v12, s71, v9
    v_fma_f32 v12, s63, v10, v12
    v_cvt_pk_bf16_f32 v11, v11, v12
    v_accvgpr_write_b32 a241, v11
    v_lshlrev_b32 v8, 2, v2
    v_add_u32 v8, 2, v8
    v_mul_u32_u24 v8, v8, v7
    v_and_b32 v8, 63, v8
    v_cvt_f32_u32 v8, v8
    v_mul_f32 v8, 0x3c800000, v8
    v_cos_f32 v9, v8
    v_sin_f32 v10, v8
    s_nop 0
    v_mul_f32 v11, s67, v9
    v_mul_f32 v12, s68, v9
    v_fma_f32 v12, s69, v10, v12
    v_cvt_pk_bf16_f32 v11, v11, v12
    v_accvgpr_write_b32 a226, v11
    v_mul_f32 v11, s70, v10
    v_mul_f32 v12, s71, v9
    v_fma_f32 v12, s63, v10, v12
    v_cvt_pk_bf16_f32 v11, v11, v12
    v_accvgpr_write_b32 a242, v11
    v_lshlrev_b32 v8, 2, v2
    v_add_u32 v8, 3, v8
    v_mul_u32_u24 v8, v8, v7
    v_and_b32 v8, 63, v8
    v_cvt_f32_u32 v8, v8
    v_mul_f32 v8, 0x3c800000, v8
    v_cos_f32 v9, v8
    v_sin_f32 v10, v8
    s_nop 0
    v_mul_f32 v11, s67, v9
    v_mul_f32 v12, s68, v9
    v_fma_f32 v12, s69, v10, v12
    v_cvt_pk_bf16_f32 v11, v11, v12
    v_accvgpr_write_b32 a227, v11
    v_mul_f32 v11, s70, v10
    v_mul_f32 v12, s71, v9
    v_fma_f32 v12, s63, v10, v12
    v_cvt_pk_bf16_f32 v11, v11, v12
    v_accvgpr_write_b32 a243, v11
    v_lshlrev_b32 v8, 2, v2
    v_add_u32 v8, 8, v8
    v_mul_u32_u24 v8, v8, v7
    v_and_b32 v8, 63, v8
    v_cvt_f32_u32 v8, v8
    v_mul_f32 v8, 0x3c800000, v8
    v_cos_f32 v9, v8
    v_sin_f32 v10, v8
    s_nop 0
    v_mul_f32 v11, s67, v9
    v_mul_f32 v12, s68, v9
    v_fma_f32 v12, s69, v10, v12
    v_cvt_pk_bf16_f32 v11, v11, v12
    v_accvgpr_write_b32 a228, v11
    v_mul_f32 v11, s70, v10
    v_mul_f32 v12, s71, v9
    v_fma_f32 v12, s63, v10, v12
    v_cvt_pk_bf16_f32 v11, v11, v12
    v_accvgpr_write_b32 a244, v11
    v_lshlrev_b32 v8, 2, v2
    v_add_u32 v8, 9, v8
    v_mul_u32_u24 v8, v8, v7
    v_and_b32 v8, 63, v8
    v_cvt_f32_u32 v8, v8
    v_mul_f32 v8, 0x3c800000, v8
    v_cos_f32 v9, v8
    v_sin_f32 v10, v8
    s_nop 0
    v_mul_f32 v11, s67, v9
    v_mul_f32 v12, s68, v9
    v_fma_f32 v12, s69, v10, v12
    v_cvt_pk_bf16_f32 v11, v11, v12
    v_accvgpr_write_b32 a229, v11
    v_mul_f32 v11, s70, v10
    v_mul_f32 v12, s71, v9
    v_fma_f32 v12, s63, v10, v12
    v_cvt_pk_bf16_f32 v11, v11, v12
    v_accvgpr_write_b32 a245, v11
    v_lshlrev_b32 v8, 2, v2
    v_add_u32 v8, 10, v8
    v_mul_u32_u24 v8, v8, v7
    v_and_b32 v8, 63, v8
    v_cvt_f32_u32 v8, v8
    v_mul_f32 v8, 0x3c800000, v8
    v_cos_f32 v9, v8
    v_sin_f32 v10, v8
    s_nop 0
    v_mul_f32 v11, s67, v9
    v_mul_f32 v12, s68, v9
    v_fma_f32 v12, s69, v10, v12
    v_cvt_pk_bf16_f32 v11, v11, v12
    v_accvgpr_write_b32 a230, v11
    v_mul_f32 v11, s70, v10
    v_mul_f32 v12, s71, v9
    v_fma_f32 v12, s63, v10, v12
    v_cvt_pk_bf16_f32 v11, v11, v12
    v_accvgpr_write_b32 a246, v11
    v_lshlrev_b32 v8, 2, v2
    v_add_u32 v8, 11, v8
    v_mul_u32_u24 v8, v8, v7
    v_and_b32 v8, 63, v8
    v_cvt_f32_u32 v8, v8
    v_mul_f32 v8, 0x3c800000, v8
    v_cos_f32 v9, v8
    v_sin_f32 v10, v8
    s_nop 0
    v_mul_f32 v11, s67, v9
    v_mul_f32 v12, s68, v9
    v_fma_f32 v12, s69, v10, v12
    v_cvt_pk_bf16_f32 v11, v11, v12
    v_accvgpr_write_b32 a231, v11
    v_mul_f32 v11, s70, v10
    v_mul_f32 v12, s71, v9
    v_fma_f32 v12, s63, v10, v12
    v_cvt_pk_bf16_f32 v11, v11, v12
    v_accvgpr_write_b32 a247, v11
    s_waitcnt vmcnt(0)
    s_barrier
    s_lshl_b32 s57, s42, 5
    s_add_u32 s57, s57, s41
    s_lshl_b32 s57, s57, 7
    s_add_u32 s57, s57, 65536
    s_or_b32 s58, s45, s47
    v_mov_b32 v4, s57
    v_mov_b32 v5, s58
    s_cmp_eq_u32 s40, 0
    s_cbranch_scc0 NF_38
    s_mov_b64 exec, 1
    buffer_store_dword v5, v4, s[32:35], 0 offen sc1
    s_mov_b64 exec, -1
NF_38:
    v_lshlrev_b32 v4, 6, v1
    v_add_u32 v4, s50, v4
    v_lshlrev_b32 v4, 10, v4
    s_bitcmp1_b32 s40, 0
    s_cbranch_scc1 RM_39
    s_lshl_b32 s57, s42, 6
    v_lshl_add_u32 v5, v2, 3, v4
    v_add_u32 v5, s57, v5
    buffer_load_dwordx2 v[16:17], v5, s[8:11], 0 offen offset:0
    buffer_load_dwordx2 v[18:19], v5, s[8:11], 0 offen offset:16
    buffer_load_dwordx2 v[20:21], v5, s[8:11], 0 offen offset:32
    buffer_load_dwordx2 v[22:23], v5, s[8:11], 0 offen offset:48
    s_branch RD_40
RM_39:
    s_lshl_b32 s57, s42, 6
    s_sub_u32 s57, 968, s57
    v_lshlrev_b32 v5, 3, v2
    v_sub_u32 v5, s57, v5
    v_add_u32 v5, v5, v4
    buffer_load_dwordx3 v[240:242], v5, s[8:11], 0 offen offset:48
    buffer_load_dwordx3 v[244:246], v5, s[8:11], 0 offen offset:32
    buffer_load_dwordx3 v[248:250], v5, s[8:11], 0 offen offset:16
    buffer_load_dwordx3 v[252:254], v5, s[8:11], 0 offen offset:0
    buffer_load_ushort v243, v4, s[8:11], 0 offen offset:512
RD_40:
    v_lshlrev_b32 v8, 2, v2
    v_add_u32 v8, 16, v8
    v_mul_u32_u24 v8, v8, v7
    v_and_b32 v8, 63, v8
    v_cvt_f32_u32 v8, v8
    v_mul_f32 v8, 0x3c800000, v8
    v_cos_f32 v9, v8
    v_sin_f32 v10, v8
    s_nop 0
    v_mul_f32 v11, s67, v9
    v_mul_f32 v12, s68, v9
    v_fma_f32 v12, s69, v10, v12
    v_cvt_pk_bf16_f32 v11, v11, v12
    v_accvgpr_write_b32 a232, v11
    v_mul_f32 v11, s70, v10
    v_mul_f32 v12, s71, v9
    v_fma_f32 v12, s63, v10, v12
    v_cvt_pk_bf16_f32 v11, v11, v12
    v_accvgpr_write_b32 a248, v11
    v_lshlrev_b32 v8, 2, v2
    v_add_u32 v8, 17, v8
    v_mul_u32_u24 v8, v8, v7
    v_and_b32 v8, 63, v8
    v_cvt_f32_u32 v8, v8
    v_mul_f32 v8, 0x3c800000, v8
    v_cos_f32 v9, v8
    v_sin_f32 v10, v8
    s_nop 0
    v_mul_f32 v11, s67, v9
    v_mul_f32 v12, s68, v9
    v_fma_f32 v12, s69, v10, v12
    v_cvt_pk_bf16_f32 v11, v11, v12
    v_accvgpr_write_b32 a233, v11
    v_mul_f32 v11, s70, v10
    v_mul_f32 v12, s71, v9
    v_fma_f32 v12, s63, v10, v12
    v_cvt_pk_bf16_f32 v11, v11, v12
    v_accvgpr_write_b32 a249, v11
    v_lshlrev_b32 v8, 2, v2
    v_add_u32 v8, 18, v8
    v_mul_u32_u24 v8, v8, v7
    v_and_b32 v8, 63, v8
    v_cvt_f32_u32 v8, v8
    v_mul_f32 v8, 0x3c800000, v8
    v_cos_f32 v9, v8
    v_sin_f32 v10, v8
    s_nop 0
    v_mul_f32 v11, s67, v9
    v_mul_f32 v12, s68, v9
    v_fma_f32 v12, s69, v10, v12
    v_cvt_pk_bf16_f32 v11, v11, v12
    v_accvgpr_write_b32 a234, v11
    v_mul_f32 v11, s70, v10
    v_mul_f32 v12, s71, v9
    v_fma_f32 v12, s63, v10, v12
    v_cvt_pk_bf16_f32 v11, v11, v12
    v_accvgpr_write_b32 a250, v11
    v_lshlrev_b32 v8, 2, v2
    v_add_u32 v8, 19, v8
    v_mul_u32_u24 v8, v8, v7
    v_and_b32 v8, 63, v8
    v_cvt_f32_u32 v8, v8
    v_mul_f32 v8, 0x3c800000, v8
    v_cos_f32 v9, v8
    v_sin_f32 v10, v8
    s_nop 0
    v_mul_f32 v11, s67, v9
    v_mul_f32 v12, s68, v9
    v_fma_f32 v12, s69, v10, v12
    v_cvt_pk_bf16_f32 v11, v11, v12
    v_accvgpr_write_b32 a235, v11
    v_mul_f32 v11, s70, v10
    v_mul_f32 v12, s71, v9
    v_fma_f32 v12, s63, v10, v12
    v_cvt_pk_bf16_f32 v11, v11, v12
    v_accvgpr_write_b32 a251, v11
    v_lshlrev_b32 v8, 2, v2
    v_add_u32 v8, 24, v8
    v_mul_u32_u24 v8, v8, v7
    v_and_b32 v8, 63, v8
    v_cvt_f32_u32 v8, v8
    v_mul_f32 v8, 0x3c800000, v8
    v_cos_f32 v9, v8
    v_sin_f32 v10, v8
    s_nop 0
    v_mul_f32 v11, s67, v9
    v_mul_f32 v12, s68, v9
    v_fma_f32 v12, s69, v10, v12
    v_cvt_pk_bf16_f32 v11, v11, v12
    v_accvgpr_write_b32 a236, v11
    v_mul_f32 v11, s70, v10
    v_mul_f32 v12, s71, v9
    v_fma_f32 v12, s63, v10, v12
    v_cvt_pk_bf16_f32 v11, v11, v12
    v_accvgpr_write_b32 a252, v11
    v_lshlrev_b32 v8, 2, v2
    v_add_u32 v8, 25, v8
    v_mul_u32_u24 v8, v8, v7
    v_and_b32 v8, 63, v8
    v_cvt_f32_u32 v8, v8
    v_mul_f32 v8, 0x3c800000, v8
    v_cos_f32 v9, v8
    v_sin_f32 v10, v8
    s_nop 0
    v_mul_f32 v11, s67, v9
    v_mul_f32 v12, s68, v9
    v_fma_f32 v12, s69, v10, v12
    v_cvt_pk_bf16_f32 v11, v11, v12
    v_accvgpr_write_b32 a237, v11
    v_mul_f32 v11, s70, v10
    v_mul_f32 v12, s71, v9
    v_fma_f32 v12, s63, v10, v12
    v_cvt_pk_bf16_f32 v11, v11, v12
    v_accvgpr_write_b32 a253, v11
    v_lshlrev_b32 v8, 2, v2
    v_add_u32 v8, 26, v8
    v_mul_u32_u24 v8, v8, v7
    v_and_b32 v8, 63, v8
    v_cvt_f32_u32 v8, v8
    v_mul_f32 v8, 0x3c800000, v8
    v_cos_f32 v9, v8
    v_sin_f32 v10, v8
    s_nop 0
    v_mul_f32 v11, s67, v9
    v_mul_f32 v12, s68, v9
    v_fma_f32 v12, s69, v10, v12
    v_cvt_pk_bf16_f32 v11, v11, v12
    v_accvgpr_write_b32 a238, v11
    v_mul_f32 v11, s70, v10
    v_mul_f32 v12, s71, v9
    v_fma_f32 v12, s63, v10, v12
    v_cvt_pk_bf16_f32 v11, v11, v12
    v_accvgpr_write_b32 a254, v11
    v_lshlrev_b32 v8, 2, v2
    v_add_u32 v8, 27, v8
    v_mul_u32_u24 v8, v8, v7
    v_and_b32 v8, 63, v8
    v_cvt_f32_u32 v8, v8
    v_mul_f32 v8, 0x3c800000, v8
    v_cos_f32 v9, v8
    v_sin_f32 v10, v8
    s_nop 0
    v_mul_f32 v11, s67, v9
    v_mul_f32 v12, s68, v9
    v_fma_f32 v12, s69, v10, v12
    v_cvt_pk_bf16_f32 v11, v11, v12
    v_accvgpr_write_b32 a239, v11
    v_mul_f32 v11, s70, v10
    v_mul_f32 v12, s71, v9
    v_fma_f32 v12, s63, v10, v12
    v_cvt_pk_bf16_f32 v11, v11, v12
    v_accvgpr_write_b32 a255, v11
    s_cmp_ge_u32 s44, 14
    s_cbranch_scc1 NCS_41
    v_and_b32 v12, 3, v0
    v_lshlrev_b32 v12, 3, v12
    v_bfe_u32 v14, v0, 4, 1
    v_lshl_add_u32 v12, v14, 5, v12
    v_bfe_u32 v13, v0, 2, 2
    v_xor_b32 v4, s40, v13
    v_lshl_add_u32 v4, v4, 6, v12
    v_lshl_add_u32 v5, v2, 2, v13
    v_lshl_add_u32 v4, v5, 8, v4
    v_add_u32 v5, 0x10000, v4
    v_mov_b32 v224, s56
    v_mov_b32 v225, s56
    v_mov_b32 v226, s56
    v_mov_b32 v227, s56
    ds_read_b64_tr_b16 v[176:177], v4 offset:0
    ds_read_b64_tr_b16 v[178:179], v4 offset:2048
    ds_read_b64_tr_b16 v[180:181], v4 offset:4096
    ds_read_b64_tr_b16 v[182:183], v4 offset:6144
    ds_read_b64_tr_b16 v[184:185], v4 offset:8192
    ds_read_b64_tr_b16 v[186:187], v4 offset:10240
    ds_read_b64_tr_b16 v[188:189], v4 offset:12288
    ds_read_b64_tr_b16 v[190:191], v4 offset:14336
    ds_read_b64_tr_b16 v[192:193], v4 offset:16384
    ds_read_b64_tr_b16 v[194:195], v4 offset:18432
    ds_read_b64_tr_b16 v[196:197], v4 offset:20480
    ds_read_b64_tr_b16 v[198:199], v4 offset:22528
    ds_read_b64_tr_b16 v[200:201], v4 offset:24576
    ds_read_b64_tr_b16 v[202:203], v4 offset:26624
    ds_read_b64_tr_b16 v[204:205], v4 offset:28672
    ds_read_b64_tr_b16 v[206:207], v4 offset:30720
    s_waitcnt lgkmcnt(14)
    v_mfma_f32_32x32x16_bf16 v[112:127], v[224:227], v[176:179], 0
    s_waitcnt lgkmcnt(12)
    v_mfma_f32_32x32x16_bf16 v[112:127], v[224:227], v[180:183], v[112:127]
    s_waitcnt lgkmcnt(10)
    v_mfma_f32_32x32x16_bf16 v[112:127], v[224:227], v[184:187], v[112:127]
    s_waitcnt lgkmcnt(8)
    v_mfma_f32_32x32x16_bf16 v[112:127], v[224:227], v[188:191], v[112:127]
    ds_read_b64_tr_b16 v[176:177], v4 offset:32768
    ds_read_b64_tr_b16 v[178:179], v4 offset:34816
    ds_read_b64_tr_b16 v[180:181], v4 offset:36864
    ds_read_b64_tr_b16 v[182:183], v4 offset:38912
    ds_read_b64_tr_b16 v[184:185], v4 offset:40960
    ds_read_b64_tr_b16 v[186:187], v4 offset:43008
    ds_read_b64_tr_b16 v[188:189], v4 offset:45056
    ds_read_b64_tr_b16 v[190:191], v4 offset:47104
    s_waitcnt lgkmcnt(14)
    v_mfma_f32_32x32x16_bf16 v[112:127], v[224:227], v[192:195], v[112:127]
    s_waitcnt lgkmcnt(12)
    v_mfma_f32_32x32x16_bf16 v[112:127], v[224:227], v[196:199], v[112:127]
    s_waitcnt lgkmcnt(10)
    v_mfma_f32_32x32x16_bf16 v[112:127], v[224:227], v[200:203], v[112:127]
    s_waitcnt lgkmcnt(8)
    v_mfma_f32_32x32x16_bf16 v[112:127], v[224:227], v[204:207], v[112:127]
    ds_read_b64_tr_b16 v[192:193], v4 offset:49152
    ds_read_b64_tr_b16 v[194:195], v4 offset:51200
    ds_read_b64_tr_b16 v[196:197], v4 offset:53248
    ds_read_b64_tr_b16 v[198:199], v4 offset:55296
    ds_read_b64_tr_b16 v[200:201], v4 offset:57344
    ds_read_b64_tr_b16 v[202:203], v4 offset:59392
    ds_read_b64_tr_b16 v[204:205], v4 offset:61440
    ds_read_b64_tr_b16 v[206:207], v4 offset:63488
    s_waitcnt lgkmcnt(14)
    v_mfma_f32_32x32x16_bf16 v[112:127], v[224:227], v[176:179], v[112:127]
    s_waitcnt lgkmcnt(12)
    v_mfma_f32_32x32x16_bf16 v[112:127], v[224:227], v[180:183], v[112:127]
    s_waitcnt lgkmcnt(10)
    v_mfma_f32_32x32x16_bf16 v[112:127], v[224:227], v[184:187], v[112:127]
    s_waitcnt lgkmcnt(8)
    v_mfma_f32_32x32x16_bf16 v[112:127], v[224:227], v[188:191], v[112:127]
    ds_read_b64_tr_b16 v[176:177], v5 offset:0
    ds_read_b64_tr_b16 v[178:179], v5 offset:2048
    ds_read_b64_tr_b16 v[180:181], v5 offset:4096
    ds_read_b64_tr_b16 v[182:183], v5 offset:6144
    ds_read_b64_tr_b16 v[184:185], v5 offset:8192
    ds_read_b64_tr_b16 v[186:187], v5 offset:10240
    ds_read_b64_tr_b16 v[188:189], v5 offset:12288
    ds_read_b64_tr_b16 v[190:191], v5 offset:14336
    s_waitcnt lgkmcnt(14)
    v_mfma_f32_32x32x16_bf16 v[112:127], v[224:227], v[192:195], v[112:127]
    s_waitcnt lgkmcnt(12)
    v_mfma_f32_32x32x16_bf16 v[112:127], v[224:227], v[196:199], v[112:127]
    s_waitcnt lgkmcnt(10)
    v_mfma_f32_32x32x16_bf16 v[112:127], v[224:227], v[200:203], v[112:127]
    s_waitcnt lgkmcnt(8)
    v_mfma_f32_32x32x16_bf16 v[112:127], v[224:227], v[204:207], v[112:127]
    ds_read_b64_tr_b16 v[192:193], v5 offset:16384
    ds_read_b64_tr_b16 v[194:195], v5 offset:18432
    ds_read_b64_tr_b16 v[196:197], v5 offset:20480
    ds_read_b64_tr_b16 v[198:199], v5 offset:22528
    ds_read_b64_tr_b16 v[200:201], v5 offset:24576
    ds_read_b64_tr_b16 v[202:203], v5 offset:26624
    ds_read_b64_tr_b16 v[204:205], v5 offset:28672
    ds_read_b64_tr_b16 v[206:207], v5 offset:30720
    s_waitcnt lgkmcnt(14)
    v_mfma_f32_32x32x16_bf16 v[112:127], v[224:227], v[176:179], v[112:127]
    s_waitcnt lgkmcnt(12)
    v_mfma_f32_32x32x16_bf16 v[112:127], v[224:227], v[180:183], v[112:127]
    s_waitcnt lgkmcnt(10)
    v_mfma_f32_32x32x16_bf16 v[112:127], v[224:227], v[184:187], v[112:127]
    s_waitcnt lgkmcnt(8)
    v_mfma_f32_32x32x16_bf16 v[112:127], v[224:227], v[188:191], v[112:127]
    ds_read_b64_tr_b16 v[176:177], v5 offset:32768
    ds_read_b64_tr_b16 v[178:179], v5 offset:34816
    ds_read_b64_tr_b16 v[180:181], v5 offset:36864
    ds_read_b64_tr_b16 v[182:183], v5 offset:38912
    ds_read_b64_tr_b16 v[184:185], v5 offset:40960
    ds_read_b64_tr_b16 v[186:187], v5 offset:43008
    ds_read_b64_tr_b16 v[188:189], v5 offset:45056
    ds_read_b64_tr_b16 v[190:191], v5 offset:47104
    s_waitcnt lgkmcnt(14)
    v_mfma_f32_32x32x16_bf16 v[112:127], v[224:227], v[192:195], v[112:127]
    s_waitcnt lgkmcnt(12)
    v_mfma_f32_32x32x16_bf16 v[112:127], v[224:227], v[196:199], v[112:127]
    s_waitcnt lgkmcnt(10)
    v_mfma_f32_32x32x16_bf16 v[112:127], v[224:227], v[200:203], v[112:127]
    s_waitcnt lgkmcnt(8)
    v_mfma_f32_32x32x16_bf16 v[112:127], v[224:227], v[204:207], v[112:127]
    ds_read_b64_tr_b16 v[192:193], v5 offset:49152
    ds_read_b64_tr_b16 v[194:195], v5 offset:51200
    ds_read_b64_tr_b16 v[196:197], v5 offset:53248
    ds_read_b64_tr_b16 v[198:199], v5 offset:55296
    ds_read_b64_tr_b16 v[200:201], v5 offset:57344
    ds_read_b64_tr_b16 v[202:203], v5 offset:59392
    ds_read_b64_tr_b16 v[204:205], v5 offset:61440
    ds_read_b64_tr_b16 v[206:207], v5 offset:63488
    s_waitcnt lgkmcnt(14)
    v_mfma_f32_32x32x16_bf16 v[112:127], v[224:227], v[176:179], v[112:127]
    s_waitcnt lgkmcnt(12)
    v_mfma_f32_32x32x16_bf16 v[112:127], v[224:227], v[180:183], v[112:127]
    s_waitcnt lgkmcnt(10)
    v_mfma_f32_32x32x16_bf16 v[112:127], v[224:227], v[184:187], v[112:127]
    s_waitcnt lgkmcnt(8)
    v_mfma_f32_32x32x16_bf16 v[112:127], v[224:227], v[188:191], v[112:127]
    s_waitcnt lgkmcnt(6)
    v_mfma_f32_32x32x16_bf16 v[112:127], v[224:227], v[192:195], v[112:127]
    s_waitcnt lgkmcnt(4)
    v_mfma_f32_32x32x16_bf16 v[112:127], v[224:227], v[196:199], v[112:127]
    s_waitcnt lgkmcnt(2)
    v_mfma_f32_32x32x16_bf16 v[112:127], v[224:227], v[200:203], v[112:127]
    s_waitcnt lgkmcnt(0)
    v_mfma_f32_32x32x16_bf16 v[112:127], v[224:227], v[204:207], v[112:127]
    v_lshlrev_b32 v4, 2, v1
    s_lshl_b32 s57, s40, 7
    s_add_u32 s57, s57, 139264
    v_add_u32 v5, s57, v4
    v_add_u32 v4, 139264, v4
    s_nop 7
    s_nop 3
    ds_write_b32 v5, v112
NCS_41:
    s_waitcnt lgkmcnt(0)
    s_barrier
    s_cmp_ge_u32 s44, 14
    s_cbranch_scc1 NCS_42
    ds_read_b32 v176, v4 offset:0
    ds_read_b32 v177, v4 offset:128
    ds_read_b32 v178, v4 offset:256
    ds_read_b32 v179, v4 offset:384
    v_cmp_gt_u32 vcc, 32, v0
    s_waitcnt lgkmcnt(0)
    v_cvt_pk_bf16_f32 v180, v176, v176
    v_and_b32 v181, 0xffff0000, v180
    v_sub_f32 v181, v176, v181
    v_mov_b32 v182, 0
    v_cvt_pk_bf16_f32 v181, v181, v182
    v_cndmask_b32 v104, 0, v180, vcc
    v_cndmask_b32 v105, 0, v181, vcc
    v_cvt_pk_bf16_f32 v180, v177, v177
    v_and_b32 v181, 0xffff0000, v180
    v_sub_f32 v181, v177, v181
    v_mov_b32 v182, 0
    v_cvt_pk_bf16_f32 v181, v181, v182
    v_cndmask_b32 v106, 0, v180, vcc
    v_cndmask_b32 v107, 0, v181, vcc
    v_cvt_pk_bf16_f32 v180, v178, v178
    v_and_b32 v181, 0xffff0000, v180
    v_sub_f32 v181, v178, v181
    v_mov_b32 v182, 0
    v_cvt_pk_bf16_f32 v181, v181, v182
    v_cndmask_b32 v108, 0, v180, vcc
    v_cndmask_b32 v109, 0, v181, vcc
    v_cvt_pk_bf16_f32 v180, v179, v179
    v_and_b32 v181, 0xffff0000, v180
    v_sub_f32 v181, v179, v181
    v_mov_b32 v182, 0
    v_cvt_pk_bf16_f32 v181, v181, v182
    v_cndmask_b32 v110, 0, v180, vcc
    v_cndmask_b32 v111, 0, v181, vcc
NCS_42:
    s_cmp_eq_u32 s40, 0
    s_cbranch_scc0 PW_43
    s_lshl_b32 s57, s42, 5
    v_add_u32 v4, s57, v1
    s_sub_u32 s57, 32, s43
    s_cmp_eq_u32 s43, 0
    s_cselect_b32 s57, 16, s57
    v_and_b32 v5, 7, v0
    v_lshlrev_b32 v5, 5, v5
    v_mov_b32 v6, s43
    v_mov_b32 v7, s57
    v_and_b32 v8, 8, v0
    v_cmp_eq_u32 vcc, 0, v8
    v_cndmask_b32 v6, v7, v6, vcc
    v_add_u32 v5, v5, v6
    v_cmp_gt_u32 vcc, 32, v0
    v_cndmask_b32 v4, v5, v4, vcc
    v_lshlrev_b32 v4, 7, v4
    v_add_u32 v4, 65536, v4
    s_mov_b32 s52, 400000
P_44:
    buffer_load_dword v5, v4, s[32:35], 0 offen sc1
    s_waitcnt vmcnt(0)
    v_and_b32 v6, 0xfffffff0, v5
    v_cmp_eq_u32 vcc, s45, v6
    s_cmp_eq_u64 vcc, -1
    s_cbranch_scc1 PD_45
    s_sub_u32 s52, s52, 1
    s_cmp_eq_u32 s52, 0
    s_cbranch_scc0 P_44
    v_mov_b32 v6, 1
    v_mov_b32 v7, 4
    buffer_store_dword v6, v7, s[36:39], 0 offen
PD_45:
    v_and_b32 v7, 15, v5
    v_cmp_eq_u32 vcc, s47, v7
    s_cmp_eq_u32 vcc_hi, -1
    s_cselect_b32 s46, 1, 0
    v_mov_b32 v7, s46
    v_mov_b32 v8, 143360
    ds_write_b32 v8, v7
PW_43:
    s_waitcnt vmcnt(0)
    s_waitcnt lgkmcnt(0)
    s_barrier
    s_lshl_b32 s57, s41, 16
    s_lshl_b32 s58, s42, 13
    s_add_u32 s57, s57, s58
    s_lshl_b32 s58, s40, 11
    s_add_u32 s57, s57, s58
    s_add_u32 s57, s57, 4194304
    s_add_u32 s58, s58, 131072
    s_add_u32 m0, s58, 0
    s_nop 0
    buffer_load_dwordx4 v3, s[32:35], s57 offen lds
    s_add_u32 s57, s57, 1024
    s_add_u32 m0, s58, 1024
    s_nop 0
    buffer_load_dwordx4 v3, s[32:35], s57 offen lds
    s_add_u32 s57, s57, 1024
    s_mul_i32 s57, s42, 229376
    s_mul_i32 s58, s40, 57344
    s_add_u32 s57, s57, s58
    s_add_u32 s57, s57, 1048576
    s_and_b32 s58, s40, 1
    s_lshl_b32 s58, s58, 12
    s_sub_u32 s57, s57, s58
    s_bitcmp1_b32 s40, 0
    s_mov_b32 s96, 2048
    s_cselect_b32 s97, 10240, s96
    s_cselect_b32 s96, s96, 10240
    s_and_b32 s58, s40, 1
    s_lshl_b32 s58, s58, 10
    s_add_u32 s53, s57, s58
    s_xor_b32 s58, s58, 1024
    s_add_u32 s54, s57, s58
    buffer_load_dwordx4 a[0:3], v3, s[32:35], s53 offen
    s_add_u32 s53, s53, 2048
    buffer_load_dwordx4 a[4:7], v3, s[32:35], s54 offen
    s_add_u32 s54, s54, 2048
    buffer_load_dwordx4 a[8:11], v3, s[32:35], s53 offen
    s_add_u32 s53, s53, s97
    buffer_load_dwordx4 a[12:15], v3, s[32:35], s54 offen
    s_add_u32 s54, s54, s97
    buffer_load_dwordx4 a[16:19], v3, s[32:35], s53 offen
    s_add_u32 s53, s53, 2048
    buffer_load_dwordx4 a[20:23], v3, s[32:35], s54 offen
    s_add_u32 s54, s54, 2048
    buffer_load_dwordx4 a[24:27], v3, s[32:35], s53 offen
    s_add_u32 s53, s53, s96
    buffer_load_dwordx4 a[28:31], v3, s[32:35], s54 offen
    s_add_u32 s54, s54, s96
    buffer_load_dwordx4 a[32:35], v3, s[32:35], s53 offen
    s_add_u32 s53, s53, 2048
    buffer_load_dwordx4 a[36:39], v3, s[32:35], s54 offen
    s_add_u32 s54, s54, 2048
    buffer_load_dwordx4 a[40:43], v3, s[32:35], s53 offen
    s_add_u32 s53, s53, s97
    buffer_load_dwordx4 a[44:47], v3, s[32:35], s54 offen
    s_add_u32 s54, s54, s97
    buffer_load_dwordx4 a[48:51], v3, s[32:35], s53 offen
    s_add_u32 s53, s53, 2048
    buffer_load_dwordx4 a[52:55], v3, s[32:35], s54 offen
    s_add_u32 s54, s54, 2048
    buffer_load_dwordx4 a[56:59], v3, s[32:35], s53 offen
    s_add_u32 s53, s53, s96
    buffer_load_dwordx4 a[60:63], v3, s[32:35], s54 offen
    s_add_u32 s54, s54, s96
    buffer_load_dwordx4 a[64:67], v3, s[32:35], s53 offen
    s_add_u32 s53, s53, 2048
    buffer_load_dwordx4 a[68:71], v3, s[32:35], s54 offen
    s_add_u32 s54, s54, 2048
    buffer_load_dwordx4 a[72:75], v3, s[32:35], s53 offen
    s_add_u32 s53, s53, s97
    buffer_load_dwordx4 a[76:79], v3, s[32:35], s54 offen
    s_add_u32 s54, s54, s97
    buffer_load_dwordx4 a[80:83], v3, s[32:35], s53 offen
    s_add_u32 s53, s53, 2048
    buffer_load_dwordx4 a[84:87], v3, s[32:35], s54 offen
    s_add_u32 s54, s54, 2048
    v_mov_b32 v8, 143360
    ds_read_b32 v7, v8
    s_waitcnt lgkmcnt(0)
    v_readfirstlane_b32 s46, v7
    s_cmp_eq_u32 s46, 1
    s_cselect_b32 s68, 0, 8388608
    s_cselect_b32 s69, 0, 0x200000
    s_mov_b32 s55, 4194304
    s_bitcmp1_b32 s40, 0
    s_cbranch_scc0 RP_46
    v_cmp_gt_u32 vcc, 32, v0
    s_cmp_eq_u32 s42, 0
    s_cselect_b64 s[64:65], -1, 0
    s_and_b64 vcc, vcc, s[64:65]
    v_cndmask_b32 v242, v242, v243, vcc
    v_mov_b32 v4, 0xffff
    v_bfi_b32 v16, v4, v242, v241
    v_bfi_b32 v17, v4, v241, v240
    v_bfi_b32 v18, v4, v246, v245
    v_bfi_b32 v19, v4, v245, v244
    v_bfi_b32 v20, v4, v250, v249
    v_bfi_b32 v21, v4, v249, v248
    v_bfi_b32 v22, v4, v254, v253
    v_bfi_b32 v23, v4, v253, v252
RP_46:
    v_lshlrev_b32 v112, 16, v16
    v_and_b32 v113, 0xffff0000, v16
    v_lshlrev_b32 v114, 16, v17
    v_and_b32 v115, 0xffff0000, v17
    v_lshlrev_b32 v116, 16, v18
    v_and_b32 v117, 0xffff0000, v18
    v_lshlrev_b32 v118, 16, v19
    v_and_b32 v119, 0xffff0000, v19
    v_lshlrev_b32 v120, 16, v20
    v_and_b32 v121, 0xffff0000, v20
    v_lshlrev_b32 v122, 16, v21
    v_and_b32 v123, 0xffff0000, v21
    v_lshlrev_b32 v124, 16, v22
    v_and_b32 v125, 0xffff0000, v22
    v_lshlrev_b32 v126, 16, v23
    v_and_b32 v127, 0xffff0000, v23
    v_mov_b32 v8, v112
    v_lshlrev_b32 v4, 10, v2
    v_lshl_add_u32 v4, v1, 2, v4
    v_add_u32 v4, 131072, v4
    s_waitcnt vmcnt(22)
    s_barrier
    ds_read_b32 v176, v4 offset:0
    ds_read_b32 v177, v4 offset:256
    ds_read_b32 v178, v4 offset:512
    ds_read_b32 v179, v4 offset:768
    ds_read_b32 v180, v4 offset:2048
    ds_read_b32 v181, v4 offset:2304
    ds_read_b32 v182, v4 offset:2560
    ds_read_b32 v183, v4 offset:2816
    s_waitcnt lgkmcnt(0)
    ds_read_b32 v184, v4 offset:4096
    ds_read_b32 v185, v4 offset:4352
    ds_read_b32 v186, v4 offset:4608
    ds_read_b32 v187, v4 offset:4864
    ds_read_b32 v188, v4 offset:6144
    ds_read_b32 v189, v4 offset:6400
    ds_read_b32 v190, v4 offset:6656
    ds_read_b32 v191, v4 offset:6912
    s_waitcnt lgkmcnt(0)
    ds_read_b32 v192, v4 offset:128
    ds_read_b32 v193, v4 offset:384
    ds_read_b32 v194, v4 offset:640
    ds_read_b32 v195, v4 offset:896
    ds_read_b32 v196, v4 offset:2176
    ds_read_b32 v197, v4 offset:2432
    ds_read_b32 v198, v4 offset:2688
    ds_read_b32 v199, v4 offset:2944
    s_waitcnt lgkmcnt(0)
    ds_read_b32 v200, v4 offset:4224
    ds_read_b32 v201, v4 offset:4480
    ds_read_b32 v202, v4 offset:4736
    ds_read_b32 v203, v4 offset:4992
    ds_read_b32 v204, v4 offset:6272
    ds_read_b32 v205, v4 offset:6528
    ds_read_b32 v206, v4 offset:6784
    ds_read_b32 v207, v4 offset:7040
    s_waitcnt lgkmcnt(0)
    v_mfma_f32_32x32x16_bf16 v[112:127], v[176:179], a[224:227], v[112:127]
    v_mfma_f32_32x32x16_bf16 v[112:127], v[180:183], a[228:231], v[112:127]
    v_mfma_f32_32x32x16_bf16 v[112:127], v[184:187], a[232:235], v[112:127]
    v_mfma_f32_32x32x16_bf16 v[112:127], v[188:191], a[236:239], v[112:127]
    v_mfma_f32_32x32x16_bf16 v[112:127], v[192:195], a[240:243], v[112:127]
    v_mfma_f32_32x32x16_bf16 v[112:127], v[196:199], a[244:247], v[112:127]
    v_mfma_f32_32x32x16_bf16 v[112:127], v[200:203], a[248:251], v[112:127]
    v_mfma_f32_32x32x16_bf16 v[112:127], v[204:207], a[252:255], v[112:127]
    s_cmp_eq_u32 s42, 0
    s_cselect_b32 s57, -1, 0
    s_bitcmp1_b32 s40, 0
    s_cselect_b32 s64, 0, s57
    s_mov_b32 s65, 0
    s_lshl_b32 s60, s50, 15
    s_lshl_b32 s57, s42, 11
    s_add_u32 s60, s60, s57
    s_and_b32 s57, s40, 1
    s_lshl_b32 s57, s57, 14
    s_add_u32 s60, s60, s57
    s_add_u32 s60, s60, 8388608
    s_nop 7
    s_nop 1
    v_cndmask_b32 v112, v112, v8, s[64:65]
    v_cvt_pk_bf16_f32 v16, v112, v113
    v_cvt_pk_bf16_f32 v17, v114, v115
    v_cvt_pk_bf16_f32 v18, v116, v117
    v_cvt_pk_bf16_f32 v19, v118, v119
    v_cvt_pk_bf16_f32 v20, v120, v121
    v_cvt_pk_bf16_f32 v21, v122, v123
    v_cvt_pk_bf16_f32 v22, v124, v125
    v_cvt_pk_bf16_f32 v23, v126, v127
    s_cmp_eq_u32 s46, 1
    s_cbranch_scc1 F_47
    buffer_store_dwordx4 v[16:19], v3, s[32:35], s60 offen offset:0 sc1
    buffer_store_dwordx4 v[20:23], v3, s[32:35], s60 offen offset:1024 sc1
    s_branch D_48
F_47:
    buffer_store_dwordx4 v[16:19], v3, s[32:35], s60 offen offset:0
    buffer_store_dwordx4 v[20:23], v3, s[32:35], s60 offen offset:1024
D_48:
    v_pk_add_f32 v[8:9], v[112:113], v[114:115]
    v_pk_mul_f32 v[10:11], v[112:113], v[112:113]
    v_pk_fma_f32 v[10:11], v[114:115], v[114:115], v[10:11]
    v_pk_add_f32 v[8:9], v[8:9], v[116:117]
    v_pk_fma_f32 v[10:11], v[116:117], v[116:117], v[10:11]
    v_pk_add_f32 v[8:9], v[8:9], v[118:119]
    v_pk_fma_f32 v[10:11], v[118:119], v[118:119], v[10:11]
    v_pk_add_f32 v[8:9], v[8:9], v[120:121]
    v_pk_fma_f32 v[10:11], v[120:121], v[120:121], v[10:11]
    v_pk_add_f32 v[8:9], v[8:9], v[122:123]
    v_pk_fma_f32 v[10:11], v[122:123], v[122:123], v[10:11]
    v_pk_add_f32 v[8:9], v[8:9], v[124:125]
    v_pk_fma_f32 v[10:11], v[124:125], v[124:125], v[10:11]
    v_pk_add_f32 v[8:9], v[8:9], v[126:127]
    v_pk_fma_f32 v[10:11], v[126:127], v[126:127], v[10:11]
    v_add_f32 v8, v8, v9
    v_add_f32 v9, v10, v11
    v_mov_b32 v10, v8
    v_mov_b32 v11, v9
    s_lshl_b32 s57, s50, 12
    s_lshl_b32 s58, s42, 9
    s_add_u32 s57, s57, s58
    s_and_b32 s58, s40, 1
    s_lshl_b32 s58, s58, 3
    s_add_u32 s57, s57, s58
    s_add_u32 s59, s57, 3145728
    v_permlane32_swap_b32 v8, v10
    v_permlane32_swap_b32 v9, v11
    v_lshlrev_b32 v12, 4, v1
    s_nop 0
    v_pk_add_f32 v[8:9], v[8:9], v[10:11]
    s_cmp_eq_u32 s46, 1
    s_cbranch_scc1 F_49
    buffer_store_dwordx2 v[8:9], v12, s[32:35], s59 offen sc1
    s_branch D_50
F_49:
    buffer_store_dwordx2 v[8:9], v12, s[32:35], s59 offen
D_50:
    s_waitcnt vmcnt(0)
    s_lshl_b32 s57, s43, 8
    s_lshl_b32 s58, s44, 4
    s_add_u32 s57, s57, s58
    s_lshl_b32 s58, s40, 2
    s_add_u32 s57, s57, s58
    s_add_u32 s57, s57, 196608
    v_mov_b32 v4, s57
    v_mov_b32 v5, s45
    s_cmp_eq_u32 s46, 1
    s_cbranch_scc1 F_51
    s_mov_b64 exec, 1
    buffer_store_dword v5, v4, s[32:35], 0 offen sc1
    s_mov_b64 exec, -1
    s_branch D_52
F_51:
    s_mov_b64 exec, 1
    buffer_store_dword v5, v4, s[32:35], 0 offen
    s_mov_b64 exec, -1
D_52:
    s_lshl_b32 s57, s43, 8
    s_add_u32 s57, s57, 196608
    v_lshlrev_b32 v4, 2, v0
    v_add_u32 v4, s57, v4
    s_mov_b32 s52, 400000
P_53:
    buffer_load_dword v5, v4, s[32:35], 0 offen sc1
    s_waitcnt vmcnt(0)
    v_and_b32 v6, 0xfffffff0, v5
    v_cmp_eq_u32 vcc, s45, v6
    s_cmp_eq_u64 vcc, -1
    s_cbranch_scc1 PD_54
    s_sub_u32 s52, s52, 1
    s_cmp_eq_u32 s52, 0
    s_cbranch_scc0 P_53
    v_mov_b32 v6, 2
    v_mov_b32 v7, 8
    buffer_store_dword v6, v7, s[36:39], 0 offen
PD_54:
    s_cmp_ge_u32 s44, 14
    s_cbranch_scc1 P3I_55
    s_lshl_b32 s57, s51, 12
    s_add_u32 s57, s57, 3145728
    v_lshlrev_b32 v14, 4, v1
    v_lshl_add_u32 v14, v2, 11, v14
    buffer_load_dwordx4 v[208:211], v14, s[32:35], s57 offen offset:0
    buffer_load_dwordx4 v[212:215], v14, s[32:35], s57 offen offset:512
    buffer_load_dwordx4 v[216:219], v14, s[32:35], s57 offen offset:1024
    buffer_load_dwordx4 v[220:223], v14, s[32:35], s57 offen offset:1536
    s_lshl_b32 s60, s51, 15
    s_add_u32 s60, s60, 8388608
    buffer_load_dwordx4 v[176:179], v3, s[32:35], s60 offen offset:0
    buffer_load_dwordx4 v[180:183], v3, s[32:35], s60 offen offset:1024
    buffer_load_dwordx4 v[184:187], v3, s[32:35], s60 offen offset:2048
    buffer_load_dwordx4 v[188:191], v3, s[32:35], s60 offen offset:3072
    s_add_u32 s60, s60, 4096
    buffer_load_dwordx4 v[192:195], v3, s[32:35], s60 offen offset:0
    buffer_load_dwordx4 v[196:199], v3, s[32:35], s60 offen offset:1024
    buffer_load_dwordx4 v[200:203], v3, s[32:35], s60 offen offset:2048
    buffer_load_dwordx4 v[204:207], v3, s[32:35], s60 offen offset:3072
    v_and_b32 v12, 3, v0
    v_lshlrev_b32 v12, 3, v12
    v_bfe_u32 v14, v0, 4, 1
    v_lshl_add_u32 v12, v14, 5, v12
    v_bfe_u32 v13, v0, 2, 2
    v_xor_b32 v4, 0, v13
    v_lshl_add_u32 v4, v4, 6, v12
    v_lshl_add_u32 v14, v2, 2, v13
    v_lshl_add_u32 v4, v14, 8, v4
    v_xor_b32 v5, 1, v13
    v_lshl_add_u32 v5, v5, 6, v12
    v_lshl_add_u32 v14, v2, 2, v13
    v_lshl_add_u32 v5, v14, 8, v5
    v_xor_b32 v6, 2, v13
    v_lshl_add_u32 v6, v6, 6, v12
    v_lshl_add_u32 v14, v2, 2, v13
    v_lshl_add_u32 v6, v14, 8, v6
    v_xor_b32 v7, 3, v13
    v_lshl_add_u32 v7, v7, 6, v12
    v_lshl_add_u32 v14, v2, 2, v13
    v_lshl_add_u32 v7, v14, 8, v7
    ds_read_b64_tr_b16 v[224:225], v4 offset:0
    ds_read_b64_tr_b16 v[226:227], v4 offset:2048
    ds_read_b64_tr_b16 v[228:229], v5 offset:0
    ds_read_b64_tr_b16 v[230:231], v5 offset:2048
    ds_read_b64_tr_b16 v[232:233], v6 offset:0
    ds_read_b64_tr_b16 v[234:235], v6 offset:2048
    ds_read_b64_tr_b16 v[236:237], v7 offset:0
    ds_read_b64_tr_b16 v[238:239], v7 offset:2048
    s_waitcnt vmcnt(7)
    s_waitcnt lgkmcnt(6)
    v_mfma_f32_32x32x16_bf16 v[112:127], v[224:227], v[176:179], 0
    ds_read_b64_tr_b16 v[240:241], v4 offset:4096
    ds_read_b64_tr_b16 v[242:243], v4 offset:6144
    s_waitcnt lgkmcnt(6)
    v_mfma_f32_32x32x16_bf16 v[128:143], v[228:231], v[176:179], 0
    ds_read_b64_tr_b16 v[244:245], v5 offset:4096
    ds_read_b64_tr_b16 v[246:247], v5 offset:6144
    s_waitcnt lgkmcnt(6)
    v_mfma_f32_32x32x16_bf16 v[144:159], v[232:235], v[176:179], 0
    ds_read_b64_tr_b16 v[248:249], v6 offset:4096
    ds_read_b64_tr_b16 v[250:251], v6 offset:6144
    s_waitcnt lgkmcnt(6)
    v_mfma_f32_32x32x16_bf16 v[160:175], v[236:239], v[176:179], 0
    ds_read_b64_tr_b16 v[252:253], v7 offset:4096
    ds_read_b64_tr_b16 v[254:255], v7 offset:6144
    s_waitcnt vmcnt(8)
    v_pk_add_f32 v[208:209], v[208:209], v[210:211]
    v_pk_add_f32 v[212:213], v[212:213], v[214:215]
    v_pk_add_f32 v[216:217], v[216:217], v[218:219]
    v_pk_add_f32 v[220:221], v[220:221], v[222:223]
    v_pk_add_f32 v[208:209], v[208:209], v[212:213]
    v_pk_add_f32 v[216:217], v[216:217], v[220:221]
    v_pk_add_f32 v[208:209], v[208:209], v[216:217]
    v_mov_b32 v210, v208
    v_mov_b32 v211, v209
    s_nop 1
    v_permlane32_swap_b32 v208, v210
    v_permlane32_swap_b32 v209, v211
    s_nop 0
    v_pk_add_f32 v[208:209], v[208:209], v[210:211]
    v_mul_f32 v8, 0x3b000000, v208
    v_mul_f32 v209, 0x3b000000, v209
    v_fma_f32 v209, -v8, v8, v209
    v_max_f32 v209, 0, v209
    v_add_f32 v209, 0x3727c5ac, v209
    v_rsq_f32 v9, v209
    s_nop 0
    v_sub_f32 v8, 0, v8
    v_cvt_pk_bf16_f32 v10, v8, v8
    v_and_b32 v11, 0xffff0000, v10
    v_sub_f32 v9, v8, v11
    v_cvt_pk_bf16_f32 v9, v9, v9
    v_and_b32 v9, 0xffff0000, v9
    v_lshrrev_b32 v11, 16, v11
    v_or_b32 v10, v11, v9
    v_cmp_gt_u32 vcc, 32, v0
    v_cndmask_b32 v210, 0, v10, vcc
    v_cndmask_b32 v211, 0, v11, vcc
    v_mov_b32 v208, 0
    v_mov_b32 v209, 0
    v_mov_b32 v212, 0
    v_mov_b32 v213, 0
    s_nop 1
    v_mfma_f32_32x32x16_bf16 v[112:127], v[104:107], v[210:213], v[112:127]
    v_mfma_f32_32x32x16_bf16 v[128:143], v[104:107], v[208:211], v[128:143]
    v_mfma_f32_32x32x16_bf16 v[144:159], v[108:111], v[210:213], v[144:159]
    v_mfma_f32_32x32x16_bf16 v[160:175], v[108:111], v[208:211], v[160:175]
    s_add_u32 s60, s60, 4096
    buffer_load_dwordx4 v[208:211], v3, s[32:35], s60 offen offset:0
    buffer_load_dwordx4 v[212:215], v3, s[32:35], s60 offen offset:1024
    buffer_load_dwordx4 v[216:219], v3, s[32:35], s60 offen offset:2048
    buffer_load_dwordx4 v[220:223], v3, s[32:35], s60 offen offset:3072
    s_add_u32 s60, s60, 4096
    buffer_load_dwordx4 v[176:179], v3, s[32:35], s60 offen offset:0
    buffer_load_dwordx4 a[88:91], v3, s[32:35], s53 offen
    s_add_u32 s53, s53, s96
    s_waitcnt vmcnt(12)
    s_waitcnt lgkmcnt(6)
    v_mfma_f32_32x32x16_bf16 v[112:127], v[240:243], v[180:183], v[112:127]
    ds_read_b64_tr_b16 v[224:225], v4 offset:8192
    ds_read_b64_tr_b16 v[226:227], v4 offset:10240
    s_waitcnt lgkmcnt(6)
    v_mfma_f32_32x32x16_bf16 v[128:143], v[244:247], v[180:183], v[128:143]
    ds_read_b64_tr_b16 v[228:229], v5 offset:8192
    ds_read_b64_tr_b16 v[230:231], v5 offset:10240
    s_waitcnt lgkmcnt(6)
    v_mfma_f32_32x32x16_bf16 v[144:159], v[248:251], v[180:183], v[144:159]
    ds_read_b64_tr_b16 v[232:233], v6 offset:8192
    ds_read_b64_tr_b16 v[234:235], v6 offset:10240
    s_waitcnt lgkmcnt(6)
    v_mfma_f32_32x32x16_bf16 v[160:175], v[252:255], v[180:183], v[160:175]
    ds_read_b64_tr_b16 v[236:237], v7 offset:8192
    ds_read_b64_tr_b16 v[238:239], v7 offset:10240
    buffer_load_dwordx4 v[180:183], v3, s[32:35], s60 offen offset:1024
    buffer_load_dwordx4 a[92:95], v3, s[32:35], s54 offen
    s_add_u32 s54, s54, s96
    s_waitcnt vmcnt(13)
    s_waitcnt lgkmcnt(6)
    v_mfma_f32_32x32x16_bf16 v[112:127], v[224:227], v[184:187], v[112:127]
    ds_read_b64_tr_b16 v[240:241], v4 offset:12288
    ds_read_b64_tr_b16 v[242:243], v4 offset:14336
    s_waitcnt lgkmcnt(6)
    v_mfma_f32_32x32x16_bf16 v[128:143], v[228:231], v[184:187], v[128:143]
    ds_read_b64_tr_b16 v[244:245], v5 offset:12288
    ds_read_b64_tr_b16 v[246:247], v5 offset:14336
    s_waitcnt lgkmcnt(6)
    v_mfma_f32_32x32x16_bf16 v[144:159], v[232:235], v[184:187], v[144:159]
    ds_read_b64_tr_b16 v[248:249], v6 offset:12288
    ds_read_b64_tr_b16 v[250:251], v6 offset:14336
    s_waitcnt lgkmcnt(6)
    v_mfma_f32_32x32x16_bf16 v[160:175], v[236:239], v[184:187], v[160:175]
    ds_read_b64_tr_b16 v[252:253], v7 offset:12288
    ds_read_b64_tr_b16 v[254:255], v7 offset:14336
    buffer_load_dwordx4 v[184:187], v3, s[32:35], s60 offen offset:2048
    buffer_load_dwordx4 a[96:99], v3, s[32:35], s53 offen
    s_add_u32 s53, s53, 2048
    s_waitcnt vmcnt(14)
    s_waitcnt lgkmcnt(6)
    v_mfma_f32_32x32x16_bf16 v[112:127], v[240:243], v[188:191], v[112:127]
    ds_read_b64_tr_b16 v[224:225], v4 offset:16384
    ds_read_b64_tr_b16 v[226:227], v4 offset:18432
    s_waitcnt lgkmcnt(6)
    v_mfma_f32_32x32x16_bf16 v[128:143], v[244:247], v[188:191], v[128:143]
    ds_read_b64_tr_b16 v[228:229], v5 offset:16384
    ds_read_b64_tr_b16 v[230:231], v5 offset:18432
    s_waitcnt lgkmcnt(6)
    v_mfma_f32_32x32x16_bf16 v[144:159], v[248:251], v[188:191], v[144:159]
    ds_read_b64_tr_b16 v[232:233], v6 offset:16384
    ds_read_b64_tr_b16 v[234:235], v6 offset:18432
    s_waitcnt lgkmcnt(6)
    v_mfma_f32_32x32x16_bf16 v[160:175], v[252:255], v[188:191], v[160:175]
    ds_read_b64_tr_b16 v[236:237], v7 offset:16384
    ds_read_b64_tr_b16 v[238:239], v7 offset:18432
    buffer_load_dwordx4 v[188:191], v3, s[32:35], s60 offen offset:3072
    buffer_load_dwordx4 a[100:103], v3, s[32:35], s54 offen
    s_add_u32 s54, s54, 2048
    s_waitcnt vmcnt(15)
    s_waitcnt lgkmcnt(6)
    v_mfma_f32_32x32x16_bf16 v[112:127], v[224:227], v[192:195], v[112:127]
    ds_read_b64_tr_b16 v[240:241], v4 offset:20480
    ds_read_b64_tr_b16 v[242:243], v4 offset:22528
    s_waitcnt lgkmcnt(6)
    v_mfma_f32_32x32x16_bf16 v[128:143], v[228:231], v[192:195], v[128:143]
    ds_read_b64_tr_b16 v[244:245], v5 offset:20480
    ds_read_b64_tr_b16 v[246:247], v5 offset:22528
    s_waitcnt lgkmcnt(6)
    v_mfma_f32_32x32x16_bf16 v[144:159], v[232:235], v[192:195], v[144:159]
    ds_read_b64_tr_b16 v[248:249], v6 offset:20480
    ds_read_b64_tr_b16 v[250:251], v6 offset:22528
    s_waitcnt lgkmcnt(6)
    v_mfma_f32_32x32x16_bf16 v[160:175], v[236:239], v[192:195], v[160:175]
    ds_read_b64_tr_b16 v[252:253], v7 offset:20480
    ds_read_b64_tr_b16 v[254:255], v7 offset:22528
    s_add_u32 s60, s60, 4096
    buffer_load_dwordx4 v[192:195], v3, s[32:35], s60 offen offset:0
    buffer_load_dwordx4 a[104:107], v3, s[32:35], s53 offen
    s_sub_u32 s53, s53, 43008
    s_waitcnt vmcnt(16)
    s_waitcnt lgkmcnt(6)
    v_mfma_f32_32x32x16_bf16 v[112:127], v[240:243], v[196:199], v[112:127]
    ds_read_b64_tr_b16 v[224:225], v4 offset:24576
    ds_read_b64_tr_b16 v[226:227], v4 offset:26624
    s_waitcnt lgkmcnt(6)
    v_mfma_f32_32x32x16_bf16 v[128:143], v[244:247], v[196:199], v[128:143]
    ds_read_b64_tr_b16 v[228:229], v5 offset:24576
    ds_read_b64_tr_b16 v[230:231], v5 offset:26624
    s_waitcnt lgkmcnt(6)
    v_mfma_f32_32x32x16_bf16 v[144:159], v[248:251], v[196:199], v[144:159]
    ds_read_b64_tr_b16 v[232:233], v6 offset:24576
    ds_read_b64_tr_b16 v[234:235], v6 offset:26624
    s_waitcnt lgkmcnt(6)
    v_mfma_f32_32x32x16_bf16 v[160:175], v[252:255], v[196:199], v[160:175]
    ds_read_b64_tr_b16 v[236:237], v7 offset:24576
    ds_read_b64_tr_b16 v[238:239], v7 offset:26624
    buffer_load_dwordx4 v[196:199], v3, s[32:35], s60 offen offset:1024
    buffer_load_dwordx4 a[108:111], v3, s[32:35], s54 offen
    s_sub_u32 s54, s54, 43008
    s_waitcnt vmcnt(17)
    s_waitcnt lgkmcnt(6)
    v_mfma_f32_32x32x16_bf16 v[112:127], v[224:227], v[200:203], v[112:127]
    ds_read_b64_tr_b16 v[240:241], v4 offset:28672
    ds_read_b64_tr_b16 v[242:243], v4 offset:30720
    s_waitcnt lgkmcnt(6)
    v_mfma_f32_32x32x16_bf16 v[128:143], v[228:231], v[200:203], v[128:143]
    ds_read_b64_tr_b16 v[244:245], v5 offset:28672
    ds_read_b64_tr_b16 v[246:247], v5 offset:30720
    s_waitcnt lgkmcnt(6)
    v_mfma_f32_32x32x16_bf16 v[144:159], v[232:235], v[200:203], v[144:159]
    ds_read_b64_tr_b16 v[248:249], v6 offset:28672
    ds_read_b64_tr_b16 v[250:251], v6 offset:30720
    s_waitcnt lgkmcnt(6)
    v_mfma_f32_32x32x16_bf16 v[160:175], v[236:239], v[200:203], v[160:175]
    ds_read_b64_tr_b16 v[252:253], v7 offset:28672
    ds_read_b64_tr_b16 v[254:255], v7 offset:30720
    buffer_load_dwordx4 v[200:203], v3, s[32:35], s60 offen offset:2048
    buffer_load_dwordx4 a[112:115], v3, s[32:35], s53 offen
    s_add_u32 s53, s53, 2048
    s_waitcnt vmcnt(18)
    s_waitcnt lgkmcnt(6)
    v_mfma_f32_32x32x16_bf16 v[112:127], v[240:243], v[204:207], v[112:127]
    ds_read_b64_tr_b16 v[224:225], v4 offset:32768
    ds_read_b64_tr_b16 v[226:227], v4 offset:34816
    s_waitcnt lgkmcnt(6)
    v_mfma_f32_32x32x16_bf16 v[128:143], v[244:247], v[204:207], v[128:143]
    ds_read_b64_tr_b16 v[228:229], v5 offset:32768
    ds_read_b64_tr_b16 v[230:231], v5 offset:34816
    s_waitcnt lgkmcnt(6)
    v_mfma_f32_32x32x16_bf16 v[144:159], v[248:251], v[204:207], v[144:159]
    ds_read_b64_tr_b16 v[232:233], v6 offset:32768
    ds_read_b64_tr_b16 v[234:235], v6 offset:34816
    s_waitcnt lgkmcnt(6)
    v_mfma_f32_32x32x16_bf16 v[160:175], v[252:255], v[204:207], v[160:175]
    ds_read_b64_tr_b16 v[236:237], v7 offset:32768
    ds_read_b64_tr_b16 v[238:239], v7 offset:34816
    buffer_load_dwordx4 v[204:207], v3, s[32:35], s60 offen offset:3072
    buffer_load_dwordx4 a[116:119], v3, s[32:35], s54 offen
    s_add_u32 s54, s54, 2048
    s_waitcnt vmcnt(19)
    s_waitcnt lgkmcnt(6)
    v_mfma_f32_32x32x16_bf16 v[112:127], v[224:227], v[208:211], v[112:127]
    ds_read_b64_tr_b16 v[240:241], v4 offset:36864
    ds_read_b64_tr_b16 v[242:243], v4 offset:38912
    s_waitcnt lgkmcnt(6)
    v_mfma_f32_32x32x16_bf16 v[128:143], v[228:231], v[208:211], v[128:143]
    ds_read_b64_tr_b16 v[244:245], v5 offset:36864
    ds_read_b64_tr_b16 v[246:247], v5 offset:38912
    s_waitcnt lgkmcnt(6)
    v_mfma_f32_32x32x16_bf16 v[144:159], v[232:235], v[208:211], v[144:159]
    ds_read_b64_tr_b16 v[248:249], v6 offset:36864
    ds_read_b64_tr_b16 v[250:251], v6 offset:38912
    s_waitcnt lgkmcnt(6)
    v_mfma_f32_32x32x16_bf16 v[160:175], v[236:239], v[208:211], v[160:175]
    ds_read_b64_tr_b16 v[252:253], v7 offset:36864
    ds_read_b64_tr_b16 v[254:255], v7 offset:38912
    s_add_u32 s60, s60, 4096
    buffer_load_dwordx4 v[208:211], v3, s[32:35], s60 offen offset:0
    buffer_load_dwordx4 a[120:123], v3, s[32:35], s53 offen
    s_add_u32 s53, s53, s97
    s_waitcnt vmcnt(20)
    s_waitcnt lgkmcnt(6)
    v_mfma_f32_32x32x16_bf16 v[112:127], v[240:243], v[212:215], v[112:127]
    ds_read_b64_tr_b16 v[224:225], v4 offset:40960
    ds_read_b64_tr_b16 v[226:227], v4 offset:43008
    s_waitcnt lgkmcnt(6)
    v_mfma_f32_32x32x16_bf16 v[128:143], v[244:247], v[212:215], v[128:143]
    ds_read_b64_tr_b16 v[228:229], v5 offset:40960
    ds_read_b64_tr_b16 v[230:231], v5 offset:43008
    s_waitcnt lgkmcnt(6)
    v_mfma_f32_32x32x16_bf16 v[144:159], v[248:251], v[212:215], v[144:159]
    ds_read_b64_tr_b16 v[232:233], v6 offset:40960
    ds_read_b64_tr_b16 v[234:235], v6 offset:43008
    s_waitcnt lgkmcnt(6)
    v_mfma_f32_32x32x16_bf16 v[160:175], v[252:255], v[212:215], v[160:175]
    ds_read_b64_tr_b16 v[236:237], v7 offset:40960
    ds_read_b64_tr_b16 v[238:239], v7 offset:43008
    buffer_load_dwordx4 v[212:215], v3, s[32:35], s60 offen offset:1024
    buffer_load_dwordx4 a[124:127], v3, s[32:35], s54 offen
    s_add_u32 s54, s54, s97
    s_waitcnt vmcnt(21)
    s_waitcnt lgkmcnt(6)
    v_mfma_f32_32x32x16_bf16 v[112:127], v[224:227], v[216:219], v[112:127]
    ds_read_b64_tr_b16 v[240:241], v4 offset:45056
    ds_read_b64_tr_b16 v[242:243], v4 offset:47104
    s_waitcnt lgkmcnt(6)
    v_mfma_f32_32x32x16_bf16 v[128:143], v[228:231], v[216:219], v[128:143]
    ds_read_b64_tr_b16 v[244:245], v5 offset:45056
    ds_read_b64_tr_b16 v[246:247], v5 offset:47104
    s_waitcnt lgkmcnt(6)
    v_mfma_f32_32x32x16_bf16 v[144:159], v[232:235], v[216:219], v[144:159]
    ds_read_b64_tr_b16 v[248:249], v6 offset:45056
    ds_read_b64_tr_b16 v[250:251], v6 offset:47104
    s_waitcnt lgkmcnt(6)
    v_mfma_f32_32x32x16_bf16 v[160:175], v[236:239], v[216:219], v[160:175]
    ds_read_b64_tr_b16 v[252:253], v7 offset:45056
    ds_read_b64_tr_b16 v[254:255], v7 offset:47104
    buffer_load_dwordx4 v[216:219], v3, s[32:35], s60 offen offset:2048
    s_waitcnt vmcnt(21)
    s_waitcnt lgkmcnt(6)
    v_mfma_f32_32x32x16_bf16 v[112:127], v[240:243], v[220:223], v[112:127]
    ds_read_b64_tr_b16 v[224:225], v4 offset:49152
    ds_read_b64_tr_b16 v[226:227], v4 offset:51200
    s_waitcnt lgkmcnt(6)
    v_mfma_f32_32x32x16_bf16 v[128:143], v[244:247], v[220:223], v[128:143]
    ds_read_b64_tr_b16 v[228:229], v5 offset:49152
    ds_read_b64_tr_b16 v[230:231], v5 offset:51200
    s_waitcnt lgkmcnt(6)
    v_mfma_f32_32x32x16_bf16 v[144:159], v[248:251], v[220:223], v[144:159]
    ds_read_b64_tr_b16 v[232:233], v6 offset:49152
    ds_read_b64_tr_b16 v[234:235], v6 offset:51200
    s_waitcnt lgkmcnt(6)
    v_mfma_f32_32x32x16_bf16 v[160:175], v[252:255], v[220:223], v[160:175]
    ds_read_b64_tr_b16 v[236:237], v7 offset:49152
    ds_read_b64_tr_b16 v[238:239], v7 offset:51200
    buffer_load_dwordx4 v[220:223], v3, s[32:35], s60 offen offset:3072
    s_waitcnt vmcnt(21)
    s_waitcnt lgkmcnt(6)
    v_mfma_f32_32x32x16_bf16 v[112:127], v[224:227], v[176:179], v[112:127]
    ds_read_b64_tr_b16 v[240:241], v4 offset:53248
    ds_read_b64_tr_b16 v[242:243], v4 offset:55296
    s_waitcnt lgkmcnt(6)
    v_mfma_f32_32x32x16_bf16 v[128:143], v[228:231], v[176:179], v[128:143]
    ds_read_b64_tr_b16 v[244:245], v5 offset:53248
    ds_read_b64_tr_b16 v[246:247], v5 offset:55296
    s_waitcnt lgkmcnt(6)
    v_mfma_f32_32x32x16_bf16 v[144:159], v[232:235], v[176:179], v[144:159]
    ds_read_b64_tr_b16 v[248:249], v6 offset:53248
    ds_read_b64_tr_b16 v[250:251], v6 offset:55296
    s_waitcnt lgkmcnt(6)
    v_mfma_f32_32x32x16_bf16 v[160:175], v[236:239], v[176:179], v[160:175]
    ds_read_b64_tr_b16 v[252:253], v7 offset:53248
    ds_read_b64_tr_b16 v[254:255], v7 offset:55296
    s_add_u32 s60, s60, 4096
    buffer_load_dwordx4 v[176:179], v3, s[32:35], s60 offen offset:0
    s_waitcnt vmcnt(20)
    s_waitcnt lgkmcnt(6)
    v_mfma_f32_32x32x16_bf16 v[112:127], v[240:243], v[180:183], v[112:127]
    ds_read_b64_tr_b16 v[224:225], v4 offset:57344
    ds_read_b64_tr_b16 v[226:227], v4 offset:59392
    s_waitcnt lgkmcnt(6)
    v_mfma_f32_32x32x16_bf16 v[128:143], v[244:247], v[180:183], v[128:143]
    ds_read_b64_tr_b16 v[228:229], v5 offset:57344
    ds_read_b64_tr_b16 v[230:231], v5 offset:59392
    s_waitcnt lgkmcnt(6)
    v_mfma_f32_32x32x16_bf16 v[144:159], v[248:251], v[180:183], v[144:159]
    ds_read_b64_tr_b16 v[232:233], v6 offset:57344
    ds_read_b64_tr_b16 v[234:235], v6 offset:59392
    s_waitcnt lgkmcnt(6)
    v_mfma_f32_32x32x16_bf16 v[160:175], v[252:255], v[180:183], v[160:175]
    ds_read_b64_tr_b16 v[236:237], v7 offset:57344
    ds_read_b64_tr_b16 v[238:239], v7 offset:59392
    buffer_load_dwordx4 v[180:183], v3, s[32:35], s60 offen offset:1024
    s_waitcnt vmcnt(19)
    s_waitcnt lgkmcnt(6)
    v_mfma_f32_32x32x16_bf16 v[112:127], v[224:227], v[184:187], v[112:127]
    ds_read_b64_tr_b16 v[240:241], v4 offset:61440
    ds_read_b64_tr_b16 v[242:243], v4 offset:63488
    s_waitcnt lgkmcnt(6)
    v_mfma_f32_32x32x16_bf16 v[128:143], v[228:231], v[184:187], v[128:143]
    ds_read_b64_tr_b16 v[244:245], v5 offset:61440
    ds_read_b64_tr_b16 v[246:247], v5 offset:63488
    s_waitcnt lgkmcnt(6)
    v_mfma_f32_32x32x16_bf16 v[144:159], v[232:235], v[184:187], v[144:159]
    ds_read_b64_tr_b16 v[248:249], v6 offset:61440
    ds_read_b64_tr_b16 v[250:251], v6 offset:63488
    s_waitcnt lgkmcnt(6)
    v_mfma_f32_32x32x16_bf16 v[160:175], v[236:239], v[184:187], v[160:175]
    ds_read_b64_tr_b16 v[252:253], v7 offset:61440
    ds_read_b64_tr_b16 v[254:255], v7 offset:63488
    buffer_load_dwordx4 v[184:187], v3, s[32:35], s60 offen offset:2048
    s_waitcnt vmcnt(18)
    s_waitcnt lgkmcnt(6)
    v_mfma_f32_32x32x16_bf16 v[112:127], v[240:243], v[188:191], v[112:127]
    v_sub_u32 v14, 4, v13
    v_and_b32 v14, 3, v14
    v_xor_b32 v14, 0, v14
    v_lshl_add_u32 v4, v14, 6, v12
    v_lshl_add_u32 v14, v2, 2, v13
    v_sub_u32 v15, 0, v14
    v_add_u32 v15, 264, v15
    v_lshl_add_u32 v4, v15, 8, v4
    v_sub_u32 v14, 4, v13
    v_and_b32 v14, 3, v14
    v_xor_b32 v14, 1, v14
    v_lshl_add_u32 v5, v14, 6, v12
    v_lshl_add_u32 v14, v2, 2, v13
    v_sub_u32 v15, 0, v14
    v_add_u32 v15, 264, v15
    v_lshl_add_u32 v5, v15, 8, v5
    v_sub_u32 v14, 4, v13
    v_and_b32 v14, 3, v14
    v_xor_b32 v14, 2, v14
    v_lshl_add_u32 v6, v14, 6, v12
    v_lshl_add_u32 v14, v2, 2, v13
    v_sub_u32 v15, 0, v14
    v_add_u32 v15, 264, v15
    v_lshl_add_u32 v6, v15, 8, v6
    v_sub_u32 v14, 4, v13
    v_and_b32 v14, 3, v14
    v_xor_b32 v14, 3, v14
    v_lshl_add_u32 v7, v14, 6, v12
    v_lshl_add_u32 v14, v2, 2, v13
    v_sub_u32 v15, 0, v14
    v_add_u32 v15, 264, v15
    v_lshl_add_u32 v7, v15, 8, v7
    v_lshl_add_u32 v14, v2, 2, v13
    v_cmp_eq_u32 vcc, 0, v14
    v_add_u32 v15, 0xffff0000, v4
    v_cndmask_b32 v15, v4, v15, vcc
    ds_read_b64_tr_b16 v[224:225], v15 offset:63488
    ds_read_b64_tr_b16 v[226:227], v4 offset:61440
    s_waitcnt lgkmcnt(6)
    v_mfma_f32_32x32x16_bf16 v[128:143], v[244:247], v[188:191], v[128:143]
    v_lshl_add_u32 v14, v2, 2, v13
    v_cmp_eq_u32 vcc, 0, v14
    v_add_u32 v15, 0xffff0000, v5
    v_cndmask_b32 v15, v5, v15, vcc
    ds_read_b64_tr_b16 v[228:229], v15 offset:63488
    ds_read_b64_tr_b16 v[230:231], v5 offset:61440
    s_waitcnt lgkmcnt(6)
    v_mfma_f32_32x32x16_bf16 v[144:159], v[248:251], v[188:191], v[144:159]
    v_lshl_add_u32 v14, v2, 2, v13
    v_cmp_eq_u32 vcc, 0, v14
    v_add_u32 v15, 0xffff0000, v6
    v_cndmask_b32 v15, v6, v15, vcc
    ds_read_b64_tr_b16 v[232:233], v15 offset:63488
    ds_read_b64_tr_b16 v[234:235], v6 offset:61440
    s_waitcnt lgkmcnt(6)
    v_mfma_f32_32x32x16_bf16 v[160:175], v[252:255], v[188:191], v[160:175]
    v_lshl_add_u32 v14, v2, 2, v13
    v_cmp_eq_u32 vcc, 0, v14
    v_add_u32 v15, 0xffff0000, v7
    v_cndmask_b32 v15, v7, v15, vcc
    ds_read_b64_tr_b16 v[236:237], v15 offset:63488
    ds_read_b64_tr_b16 v[238:239], v7 offset:61440
    buffer_load_dwordx4 v[188:191], v3, s[32:35], s60 offen offset:3072
    s_waitcnt vmcnt(17)
    s_waitcnt lgkmcnt(6)
    v_mfma_f32_32x32x16_bf16 v[112:127], v[224:227], v[192:195], v[112:127]
    ds_read_b64_tr_b16 v[240:241], v4 offset:59392
    ds_read_b64_tr_b16 v[242:243], v4 offset:57344
    s_waitcnt lgkmcnt(6)
    v_mfma_f32_32x32x16_bf16 v[128:143], v[228:231], v[192:195], v[128:143]
    ds_read_b64_tr_b16 v[244:245], v5 offset:59392
    ds_read_b64_tr_b16 v[246:247], v5 offset:57344
    s_waitcnt lgkmcnt(6)
    v_mfma_f32_32x32x16_bf16 v[144:159], v[232:235], v[192:195], v[144:159]
    ds_read_b64_tr_b16 v[248:249], v6 offset:59392
    ds_read_b64_tr_b16 v[250:251], v6 offset:57344
    s_waitcnt lgkmcnt(6)
    v_mfma_f32_32x32x16_bf16 v[160:175], v[236:239], v[192:195], v[160:175]
    ds_read_b64_tr_b16 v[252:253], v7 offset:59392
    ds_read_b64_tr_b16 v[254:255], v7 offset:57344
    s_add_u32 s60, s60, 4096
    buffer_load_dwordx4 v[192:195], v3, s[32:35], s60 offen offset:0
    s_waitcnt vmcnt(16)
    s_waitcnt lgkmcnt(6)
    v_mfma_f32_32x32x16_bf16 v[112:127], v[240:243], v[196:199], v[112:127]
    ds_read_b64_tr_b16 v[224:225], v4 offset:55296
    ds_read_b64_tr_b16 v[226:227], v4 offset:53248
    s_waitcnt lgkmcnt(6)
    v_mfma_f32_32x32x16_bf16 v[128:143], v[244:247], v[196:199], v[128:143]
    ds_read_b64_tr_b16 v[228:229], v5 offset:55296
    ds_read_b64_tr_b16 v[230:231], v5 offset:53248
    s_waitcnt lgkmcnt(6)
    v_mfma_f32_32x32x16_bf16 v[144:159], v[248:251], v[196:199], v[144:159]
    ds_read_b64_tr_b16 v[232:233], v6 offset:55296
    ds_read_b64_tr_b16 v[234:235], v6 offset:53248
    s_waitcnt lgkmcnt(6)
    v_mfma_f32_32x32x16_bf16 v[160:175], v[252:255], v[196:199], v[160:175]
    ds_read_b64_tr_b16 v[236:237], v7 offset:55296
    ds_read_b64_tr_b16 v[238:239], v7 offset:53248
    buffer_load_dwordx4 v[196:199], v3, s[32:35], s60 offen offset:1024
    s_waitcnt vmcnt(15)
    s_waitcnt lgkmcnt(6)
    v_mfma_f32_32x32x16_bf16 v[112:127], v[224:227], v[200:203], v[112:127]
    ds_read_b64_tr_b16 v[240:241], v4 offset:51200
    ds_read_b64_tr_b16 v[242:243], v4 offset:49152
    s_waitcnt lgkmcnt(6)
    v_mfma_f32_32x32x16_bf16 v[128:143], v[228:231], v[200:203], v[128:143]
    ds_read_b64_tr_b16 v[244:245], v5 offset:51200
    ds_read_b64_tr_b16 v[246:247], v5 offset:49152
    s_waitcnt lgkmcnt(6)
    v_mfma_f32_32x32x16_bf16 v[144:159], v[232:235], v[200:203], v[144:159]
    ds_read_b64_tr_b16 v[248:249], v6 offset:51200
    ds_read_b64_tr_b16 v[250:251], v6 offset:49152
    s_waitcnt lgkmcnt(6)
    v_mfma_f32_32x32x16_bf16 v[160:175], v[236:239], v[200:203], v[160:175]
    ds_read_b64_tr_b16 v[252:253], v7 offset:51200
    ds_read_b64_tr_b16 v[254:255], v7 offset:49152
    buffer_load_dwordx4 v[200:203], v3, s[32:35], s60 offen offset:2048
    s_waitcnt vmcnt(14)
    s_waitcnt lgkmcnt(6)
    v_mfma_f32_32x32x16_bf16 v[112:127], v[240:243], v[204:207], v[112:127]
    ds_read_b64_tr_b16 v[224:225], v4 offset:47104
    ds_read_b64_tr_b16 v[226:227], v4 offset:45056
    s_waitcnt lgkmcnt(6)
    v_mfma_f32_32x32x16_bf16 v[128:143], v[244:247], v[204:207], v[128:143]
    ds_read_b64_tr_b16 v[228:229], v5 offset:47104
    ds_read_b64_tr_b16 v[230:231], v5 offset:45056
    s_waitcnt lgkmcnt(6)
    v_mfma_f32_32x32x16_bf16 v[144:159], v[248:251], v[204:207], v[144:159]
    ds_read_b64_tr_b16 v[232:233], v6 offset:47104
    ds_read_b64_tr_b16 v[234:235], v6 offset:45056
    s_waitcnt lgkmcnt(6)
    v_mfma_f32_32x32x16_bf16 v[160:175], v[252:255], v[204:207], v[160:175]
    ds_read_b64_tr_b16 v[236:237], v7 offset:47104
    ds_read_b64_tr_b16 v[238:239], v7 offset:45056
    buffer_load_dwordx4 v[204:207], v3, s[32:35], s60 offen offset:3072
    s_waitcnt vmcnt(13)
    s_waitcnt lgkmcnt(6)
    v_mfma_f32_32x32x16_bf16 v[112:127], v[224:227], v[208:211], v[112:127]
    ds_read_b64_tr_b16 v[240:241], v4 offset:43008
    ds_read_b64_tr_b16 v[242:243], v4 offset:40960
    s_waitcnt lgkmcnt(6)
    v_mfma_f32_32x32x16_bf16 v[128:143], v[228:231], v[208:211], v[128:143]
    ds_read_b64_tr_b16 v[244:245], v5 offset:43008
    ds_read_b64_tr_b16 v[246:247], v5 offset:40960
    s_waitcnt lgkmcnt(6)
    v_mfma_f32_32x32x16_bf16 v[144:159], v[232:235], v[208:211], v[144:159]
    ds_read_b64_tr_b16 v[248:249], v6 offset:43008
    ds_read_b64_tr_b16 v[250:251], v6 offset:40960
    s_waitcnt lgkmcnt(6)
    v_mfma_f32_32x32x16_bf16 v[160:175], v[236:239], v[208:211], v[160:175]
    ds_read_b64_tr_b16 v[252:253], v7 offset:43008
    ds_read_b64_tr_b16 v[254:255], v7 offset:40960
    buffer_load_dwordx4 a[128:131], v3, s[32:35], s53 offen
    s_add_u32 s53, s53, 2048
    buffer_load_dwordx4 a[132:135], v3, s[32:35], s54 offen
    s_add_u32 s54, s54, 2048
    s_waitcnt vmcnt(13)
    s_waitcnt lgkmcnt(6)
    v_mfma_f32_32x32x16_bf16 v[112:127], v[240:243], v[212:215], v[112:127]
    ds_read_b64_tr_b16 v[224:225], v4 offset:38912
    ds_read_b64_tr_b16 v[226:227], v4 offset:36864
    s_waitcnt lgkmcnt(6)
    v_mfma_f32_32x32x16_bf16 v[128:143], v[244:247], v[212:215], v[128:143]
    ds_read_b64_tr_b16 v[228:229], v5 offset:38912
    ds_read_b64_tr_b16 v[230:231], v5 offset:36864
    s_waitcnt lgkmcnt(6)
    v_mfma_f32_32x32x16_bf16 v[144:159], v[248:251], v[212:215], v[144:159]
    ds_read_b64_tr_b16 v[232:233], v6 offset:38912
    ds_read_b64_tr_b16 v[234:235], v6 offset:36864
    s_waitcnt lgkmcnt(6)
    v_mfma_f32_32x32x16_bf16 v[160:175], v[252:255], v[212:215], v[160:175]
    ds_read_b64_tr_b16 v[236:237], v7 offset:38912
    ds_read_b64_tr_b16 v[238:239], v7 offset:36864
    buffer_load_dwordx4 a[136:139], v3, s[32:35], s53 offen
    s_add_u32 s53, s53, s96
    buffer_load_dwordx4 a[140:143], v3, s[32:35], s54 offen
    s_add_u32 s54, s54, s96
    s_waitcnt vmcnt(13)
    s_waitcnt lgkmcnt(6)
    v_mfma_f32_32x32x16_bf16 v[112:127], v[224:227], v[216:219], v[112:127]
    ds_read_b64_tr_b16 v[240:241], v4 offset:34816
    ds_read_b64_tr_b16 v[242:243], v4 offset:32768
    s_waitcnt lgkmcnt(6)
    v_mfma_f32_32x32x16_bf16 v[128:143], v[228:231], v[216:219], v[128:143]
    ds_read_b64_tr_b16 v[244:245], v5 offset:34816
    ds_read_b64_tr_b16 v[246:247], v5 offset:32768
    s_waitcnt lgkmcnt(6)
    v_mfma_f32_32x32x16_bf16 v[144:159], v[232:235], v[216:219], v[144:159]
    ds_read_b64_tr_b16 v[248:249], v6 offset:34816
    ds_read_b64_tr_b16 v[250:251], v6 offset:32768
    s_waitcnt lgkmcnt(6)
    v_mfma_f32_32x32x16_bf16 v[160:175], v[236:239], v[216:219], v[160:175]
    ds_read_b64_tr_b16 v[252:253], v7 offset:34816
    ds_read_b64_tr_b16 v[254:255], v7 offset:32768
    buffer_load_dwordx4 a[144:147], v3, s[32:35], s53 offen
    s_add_u32 s53, s53, 2048
    buffer_load_dwordx4 a[148:151], v3, s[32:35], s54 offen
    s_add_u32 s54, s54, 2048
    s_waitcnt vmcnt(14)
    s_waitcnt lgkmcnt(6)
    v_mfma_f32_32x32x16_bf16 v[112:127], v[240:243], v[220:223], v[112:127]
    ds_read_b64_tr_b16 v[224:225], v4 offset:30720
    ds_read_b64_tr_b16 v[226:227], v4 offset:28672
    s_waitcnt lgkmcnt(6)
    v_mfma_f32_32x32x16_bf16 v[128:143], v[244:247], v[220:223], v[128:143]
    ds_read_b64_tr_b16 v[228:229], v5 offset:30720
    ds_read_b64_tr_b16 v[230:231], v5 offset:28672
    s_waitcnt lgkmcnt(6)
    v_mfma_f32_32x32x16_bf16 v[144:159], v[248:251], v[220:223], v[144:159]
    ds_read_b64_tr_b16 v[232:233], v6 offset:30720
    ds_read_b64_tr_b16 v[234:235], v6 offset:28672
    s_waitcnt lgkmcnt(6)
    v_mfma_f32_32x32x16_bf16 v[160:175], v[252:255], v[220:223], v[160:175]
    ds_read_b64_tr_b16 v[236:237], v7 offset:30720
    ds_read_b64_tr_b16 v[238:239], v7 offset:28672
    buffer_load_dwordx4 a[152:155], v3, s[32:35], s53 offen
    s_add_u32 s53, s53, s97
    buffer_load_dwordx4 a[156:159], v3, s[32:35], s54 offen
    s_add_u32 s54, s54, s97
    s_waitcnt vmcnt(15)
    s_waitcnt lgkmcnt(6)
    v_mfma_f32_32x32x16_bf16 v[112:127], v[224:227], v[176:179], v[112:127]
    ds_read_b64_tr_b16 v[240:241], v4 offset:26624
    ds_read_b64_tr_b16 v[242:243], v4 offset:24576
    s_waitcnt lgkmcnt(6)
    v_mfma_f32_32x32x16_bf16 v[128:143], v[228:231], v[176:179], v[128:143]
    ds_read_b64_tr_b16 v[244:245], v5 offset:26624
    ds_read_b64_tr_b16 v[246:247], v5 offset:24576
    s_waitcnt lgkmcnt(6)
    v_mfma_f32_32x32x16_bf16 v[144:159], v[232:235], v[176:179], v[144:159]
    ds_read_b64_tr_b16 v[248:249], v6 offset:26624
    ds_read_b64_tr_b16 v[250:251], v6 offset:24576
    s_waitcnt lgkmcnt(6)
    v_mfma_f32_32x32x16_bf16 v[160:175], v[236:239], v[176:179], v[160:175]
    ds_read_b64_tr_b16 v[252:253], v7 offset:26624
    ds_read_b64_tr_b16 v[254:255], v7 offset:24576
    buffer_load_dwordx4 a[160:163], v3, s[32:35], s53 offen
    s_add_u32 s53, s53, 2048
    buffer_load_dwordx4 a[164:167], v3, s[32:35], s54 offen
    s_add_u32 s54, s54, 2048
    s_lshl_b32 s57, s44, 2
    s_add_u32 s57, s57, 0
    s_mul_i32 s58, s57, 4682
    s_lshr_b32 s58, s58, 16
    s_mul_i32 s58, s58, 14
    s_add_u32 s57, s57, s58
    s_lshl_b32 s57, s57, 10
    s_mul_i32 s58, s51, 114688
    s_add_u32 s57, s57, s58
    s_add_u32 s63, s57, 16777216
    s_waitcnt vmcnt(16)
    s_waitcnt lgkmcnt(6)
    v_mfma_f32_32x32x16_bf16 v[112:127], v[240:243], v[180:183], v[112:127]
    ds_read_b64_tr_b16 v[224:225], v4 offset:22528
    ds_read_b64_tr_b16 v[226:227], v4 offset:20480
    s_waitcnt lgkmcnt(6)
    v_mfma_f32_32x32x16_bf16 v[128:143], v[244:247], v[180:183], v[128:143]
    ds_read_b64_tr_b16 v[228:229], v5 offset:22528
    ds_read_b64_tr_b16 v[230:231], v5 offset:20480
    s_waitcnt lgkmcnt(6)
    v_mfma_f32_32x32x16_bf16 v[144:159], v[248:251], v[180:183], v[144:159]
    ds_read_b64_tr_b16 v[232:233], v6 offset:22528
    ds_read_b64_tr_b16 v[234:235], v6 offset:20480
    s_waitcnt lgkmcnt(6)
    v_mfma_f32_32x32x16_bf16 v[160:175], v[252:255], v[180:183], v[160:175]
    ds_read_b64_tr_b16 v[236:237], v7 offset:22528
    ds_read_b64_tr_b16 v[238:239], v7 offset:20480
    buffer_load_dwordx4 a[168:171], v3, s[32:35], s53 offen
    s_add_u32 s53, s53, s96
    buffer_load_dwordx4 a[172:175], v3, s[32:35], s54 offen
    s_add_u32 s54, s54, s96
    s_lshl_b32 s57, s44, 2
    s_add_u32 s57, s57, 2
    s_mul_i32 s58, s57, 4682
    s_lshr_b32 s58, s58, 16
    s_mul_i32 s58, s58, 14
    s_add_u32 s57, s57, s58
    s_lshl_b32 s57, s57, 10
    s_mul_i32 s58, s51, 114688
    s_add_u32 s57, s57, s58
    s_add_u32 s66, s57, 16777216
    s_waitcnt vmcnt(17)
    s_waitcnt lgkmcnt(6)
    v_mfma_f32_32x32x16_bf16 v[112:127], v[224:227], v[184:187], v[112:127]
    ds_read_b64_tr_b16 v[240:241], v4 offset:18432
    ds_read_b64_tr_b16 v[242:243], v4 offset:16384
    s_waitcnt lgkmcnt(6)
    v_mfma_f32_32x32x16_bf16 v[128:143], v[228:231], v[184:187], v[128:143]
    ds_read_b64_tr_b16 v[244:245], v5 offset:18432
    ds_read_b64_tr_b16 v[246:247], v5 offset:16384
    s_waitcnt lgkmcnt(6)
    v_mfma_f32_32x32x16_bf16 v[144:159], v[232:235], v[184:187], v[144:159]
    ds_read_b64_tr_b16 v[248:249], v6 offset:18432
    ds_read_b64_tr_b16 v[250:251], v6 offset:16384
    s_waitcnt lgkmcnt(6)
    v_mfma_f32_32x32x16_bf16 v[160:175], v[236:239], v[184:187], v[160:175]
    ds_read_b64_tr_b16 v[252:253], v7 offset:18432
    ds_read_b64_tr_b16 v[254:255], v7 offset:16384
    buffer_load_dwordx4 a[176:179], v3, s[32:35], s53 offen
    s_add_u32 s53, s53, 2048
    buffer_load_dwordx4 a[180:183], v3, s[32:35], s54 offen
    s_add_u32 s54, s54, 2048
    s_lshl_b32 s57, s44, 2
    s_add_u32 s57, s57, 0
    s_mul_i32 s58, s57, 4682
    s_lshr_b32 s58, s58, 16
    s_mul_i32 s58, s58, 14
    s_add_u32 s57, s57, s58
    s_lshl_b32 s57, s57, 10
    s_mul_i32 s58, s51, 114688
    s_add_u32 s57, s57, s58
    s_add_u32 s70, s57, 16791552
    s_waitcnt vmcnt(18)
    s_waitcnt lgkmcnt(6)
    v_mfma_f32_32x32x16_bf16 v[112:127], v[240:243], v[188:191], v[112:127]
    ds_read_b64_tr_b16 v[224:225], v4 offset:14336
    ds_read_b64_tr_b16 v[226:227], v4 offset:12288
    s_waitcnt lgkmcnt(6)
    v_mfma_f32_32x32x16_bf16 v[128:143], v[244:247], v[188:191], v[128:143]
    ds_read_b64_tr_b16 v[228:229], v5 offset:14336
    ds_read_b64_tr_b16 v[230:231], v5 offset:12288
    s_waitcnt lgkmcnt(6)
    v_mfma_f32_32x32x16_bf16 v[144:159], v[248:251], v[188:191], v[144:159]
    ds_read_b64_tr_b16 v[232:233], v4 offset:10240
    ds_read_b64_tr_b16 v[234:235], v4 offset:8192
    s_waitcnt lgkmcnt(6)
    v_mfma_f32_32x32x16_bf16 v[160:175], v[252:255], v[188:191], v[160:175]
    ds_read_b64_tr_b16 v[236:237], v5 offset:10240
    ds_read_b64_tr_b16 v[238:239], v5 offset:8192
    buffer_load_dwordx4 a[184:187], v3, s[32:35], s53 offen
    s_add_u32 s53, s53, s97
    buffer_load_dwordx4 a[188:191], v3, s[32:35], s54 offen
    s_add_u32 s54, s54, s97
    s_lshl_b32 s57, s44, 2
    s_add_u32 s57, s57, 2
    s_mul_i32 s58, s57, 4682
    s_lshr_b32 s58, s58, 16
    s_mul_i32 s58, s58, 14
    s_add_u32 s57, s57, s58
    s_lshl_b32 s57, s57, 10
    s_mul_i32 s58, s51, 114688
    s_add_u32 s57, s57, s58
    s_add_u32 s71, s57, 16791552
    s_waitcnt vmcnt(19)
    s_waitcnt lgkmcnt(6)
    v_mfma_f32_32x32x16_bf16 v[112:127], v[224:227], v[192:195], v[112:127]
    ds_read_b64_tr_b16 v[240:241], v4 offset:6144
    ds_read_b64_tr_b16 v[242:243], v4 offset:4096
    s_waitcnt lgkmcnt(6)
    v_mfma_f32_32x32x16_bf16 v[128:143], v[228:231], v[192:195], v[128:143]
    ds_read_b64_tr_b16 v[244:245], v5 offset:6144
    ds_read_b64_tr_b16 v[246:247], v5 offset:4096
    s_waitcnt vmcnt(18)
    s_waitcnt lgkmcnt(6)
    v_mfma_f32_32x32x16_bf16 v[112:127], v[232:235], v[196:199], v[112:127]
    ds_read_b64_tr_b16 v[248:249], v4 offset:2048
    ds_read_b64_tr_b16 v[250:251], v4 offset:0
    s_waitcnt lgkmcnt(6)
    v_mfma_f32_32x32x16_bf16 v[128:143], v[236:239], v[196:199], v[128:143]
    ds_read_b64_tr_b16 v[252:253], v5 offset:2048
    ds_read_b64_tr_b16 v[254:255], v5 offset:0
    buffer_load_dwordx4 a[192:195], v3, s[32:35], s53 offen
    s_add_u32 s53, s53, 2048
    buffer_load_dwordx4 a[196:199], v3, s[32:35], s54 offen
    s_add_u32 s54, s54, 2048
    s_waitcnt vmcnt(19)
    s_waitcnt lgkmcnt(6)
    v_mfma_f32_32x32x16_bf16 v[112:127], v[240:243], v[200:203], v[112:127]
    ds_read_b64_tr_b16 v[224:225], v6 offset:14336
    ds_read_b64_tr_b16 v[226:227], v6 offset:12288
    s_waitcnt lgkmcnt(6)
    v_mfma_f32_32x32x16_bf16 v[128:143], v[244:247], v[200:203], v[128:143]
    ds_read_b64_tr_b16 v[228:229], v7 offset:14336
    ds_read_b64_tr_b16 v[230:231], v7 offset:12288
    s_waitcnt vmcnt(18)
    s_waitcnt lgkmcnt(6)
    v_mfma_f32_32x32x16_bf16 v[112:127], v[248:251], v[204:207], v[112:127]
    ds_read_b64_tr_b16 v[232:233], v6 offset:10240
    ds_read_b64_tr_b16 v[234:235], v6 offset:8192
    s_waitcnt lgkmcnt(6)
    v_mfma_f32_32x32x16_bf16 v[128:143], v[252:255], v[204:207], v[128:143]
    ds_read_b64_tr_b16 v[236:237], v7 offset:10240
    ds_read_b64_tr_b16 v[238:239], v7 offset:8192
    buffer_load_dwordx4 a[200:203], v3, s[32:35], s53 offen
    s_add_u32 s53, s53, s96
    buffer_load_dwordx4 a[204:207], v3, s[32:35], s54 offen
    s_add_u32 s54, s54, s96
    s_waitcnt lgkmcnt(6)
    v_mfma_f32_32x32x16_bf16 v[144:159], v[224:227], v[192:195], v[144:159]
    ds_read_b64_tr_b16 v[240:241], v6 offset:6144
    ds_read_b64_tr_b16 v[242:243], v6 offset:4096
    s_waitcnt lgkmcnt(6)
    v_mfma_f32_32x32x16_bf16 v[160:175], v[228:231], v[192:195], v[160:175]
    ds_read_b64_tr_b16 v[244:245], v7 offset:6144
    ds_read_b64_tr_b16 v[246:247], v7 offset:4096
    s_waitcnt lgkmcnt(6)
    v_mfma_f32_32x32x16_bf16 v[144:159], v[232:235], v[196:199], v[144:159]
    ds_read_b64_tr_b16 v[248:249], v6 offset:2048
    ds_read_b64_tr_b16 v[250:251], v6 offset:0
    v_cvt_pk_bf16_f32 v112, v112, v113
    v_cvt_pk_bf16_f32 v113, v114, v115
    v_cvt_pk_bf16_f32 v114, v116, v117
    v_cvt_pk_bf16_f32 v115, v118, v119
    v_cvt_pk_bf16_f32 v116, v120, v121
    v_cvt_pk_bf16_f32 v117, v122, v123
    v_cvt_pk_bf16_f32 v118, v124, v125
    v_cvt_pk_bf16_f32 v119, v126, v127
    s_waitcnt lgkmcnt(6)
    v_mfma_f32_32x32x16_bf16 v[160:175], v[236:239], v[196:199], v[160:175]
    ds_read_b64_tr_b16 v[252:253], v7 offset:2048
    ds_read_b64_tr_b16 v[254:255], v7 offset:0
    v_pk_max_i16 v112, v112, 0
    v_pk_max_i16 v113, v113, 0
    v_pk_max_i16 v114, v114, 0
    v_pk_max_i16 v115, v115, 0
    v_pk_max_i16 v116, v116, 0
    v_pk_max_i16 v117, v117, 0
    v_pk_max_i16 v118, v118, 0
    v_pk_max_i16 v119, v119, 0
    s_cmp_eq_u32 s46, 1
    s_cbranch_scc1 F_57
    buffer_store_dwordx4 v[112:115], v3, s[32:35], s63 offen offset:0 sc1
    buffer_store_dwordx4 v[116:119], v3, s[32:35], s63 offen offset:1024 sc1
    s_branch D_58
F_57:
    buffer_store_dwordx4 v[112:115], v3, s[32:35], s63 offen offset:0
    buffer_store_dwordx4 v[116:119], v3, s[32:35], s63 offen offset:1024
D_58:
    buffer_load_dwordx4 a[208:211], v3, s[32:35], s53 offen
    s_add_u32 s53, s53, 2048
    buffer_load_dwordx4 a[212:215], v3, s[32:35], s54 offen
    s_add_u32 s54, s54, 2048
    s_waitcnt lgkmcnt(6)
    v_mfma_f32_32x32x16_bf16 v[144:159], v[240:243], v[200:203], v[144:159]
    v_cvt_pk_bf16_f32 v128, v128, v129
    v_cvt_pk_bf16_f32 v129, v130, v131
    v_cvt_pk_bf16_f32 v130, v132, v133
    v_cvt_pk_bf16_f32 v131, v134, v135
    v_cvt_pk_bf16_f32 v132, v136, v137
    v_cvt_pk_bf16_f32 v133, v138, v139
    v_cvt_pk_bf16_f32 v134, v140, v141
    v_cvt_pk_bf16_f32 v135, v142, v143
    s_waitcnt lgkmcnt(4)
    v_mfma_f32_32x32x16_bf16 v[160:175], v[244:247], v[200:203], v[160:175]
    v_pk_max_i16 v128, v128, 0
    v_pk_max_i16 v129, v129, 0
    v_pk_max_i16 v130, v130, 0
    v_pk_max_i16 v131, v131, 0
    v_pk_max_i16 v132, v132, 0
    v_pk_max_i16 v133, v133, 0
    v_pk_max_i16 v134, v134, 0
    v_pk_max_i16 v135, v135, 0
    s_cmp_eq_u32 s46, 1
    s_cbranch_scc1 F_59
    buffer_store_dwordx4 v[128:131], v3, s[32:35], s66 offen offset:0 sc1
    buffer_store_dwordx4 v[132:135], v3, s[32:35], s66 offen offset:1024 sc1
    s_branch D_60
F_59:
    buffer_store_dwordx4 v[128:131], v3, s[32:35], s66 offen offset:0
    buffer_store_dwordx4 v[132:135], v3, s[32:35], s66 offen offset:1024
D_60:
    s_waitcnt lgkmcnt(2)
    v_mfma_f32_32x32x16_bf16 v[144:159], v[248:251], v[204:207], v[144:159]
    s_waitcnt lgkmcnt(0)
    v_mfma_f32_32x32x16_bf16 v[160:175], v[252:255], v[204:207], v[160:175]
    buffer_load_dwordx4 a[216:219], v3, s[32:35], s53 offen
    s_add_u32 s53, s53, s97
    buffer_load_dwordx4 a[220:223], v3, s[32:35], s54 offen
    s_add_u32 s54, s54, s97
    s_nop 6
    s_nop 1
    v_cvt_pk_bf16_f32 v144, v144, v145
    v_cvt_pk_bf16_f32 v145, v146, v147
    v_cvt_pk_bf16_f32 v146, v148, v149
    v_cvt_pk_bf16_f32 v147, v150, v151
    v_cvt_pk_bf16_f32 v148, v152, v153
    v_cvt_pk_bf16_f32 v149, v154, v155
    v_cvt_pk_bf16_f32 v150, v156, v157
    v_cvt_pk_bf16_f32 v151, v158, v159
    v_pk_max_i16 v144, v144, 0
    v_pk_max_i16 v145, v145, 0
    v_pk_max_i16 v146, v146, 0
    v_pk_max_i16 v147, v147, 0
    v_pk_max_i16 v148, v148, 0
    v_pk_max_i16 v149, v149, 0
    v_pk_max_i16 v150, v150, 0
    v_pk_max_i16 v151, v151, 0
    s_cmp_eq_u32 s46, 1
    s_cbranch_scc1 F_61
    buffer_store_dwordx4 v[144:147], v3, s[32:35], s70 offen offset:0 sc1
    buffer_store_dwordx4 v[148:151], v3, s[32:35], s70 offen offset:1024 sc1
    s_branch D_62
F_61:
    buffer_store_dwordx4 v[144:147], v3, s[32:35], s70 offen offset:0
    buffer_store_dwordx4 v[148:151], v3, s[32:35], s70 offen offset:1024
D_62:
    v_cvt_pk_bf16_f32 v160, v160, v161
    v_cvt_pk_bf16_f32 v161, v162, v163
    v_cvt_pk_bf16_f32 v162, v164, v165
    v_cvt_pk_bf16_f32 v163, v166, v167
    v_cvt_pk_bf16_f32 v164, v168, v169
    v_cvt_pk_bf16_f32 v165, v170, v171
    v_cvt_pk_bf16_f32 v166, v172, v173
    v_cvt_pk_bf16_f32 v167, v174, v175
    v_pk_max_i16 v160, v160, 0
    v_pk_max_i16 v161, v161, 0
    v_pk_max_i16 v162, v162, 0
    v_pk_max_i16 v163, v163, 0
    v_pk_max_i16 v164, v164, 0
    v_pk_max_i16 v165, v165, 0
    v_pk_max_i16 v166, v166, 0
    v_pk_max_i16 v167, v167, 0
    s_cmp_eq_u32 s46, 1
    s_cbranch_scc1 F_63
    buffer_store_dwordx4 v[160:163], v3, s[32:35], s71 offen offset:0 sc1
    buffer_store_dwordx4 v[164:167], v3, s[32:35], s71 offen offset:1024 sc1
    s_branch D_64
F_63:
    buffer_store_dwordx4 v[160:163], v3, s[32:35], s71 offen offset:0
    buffer_store_dwordx4 v[164:167], v3, s[32:35], s71 offen offset:1024
D_64:
    s_branch P3D_56
P3I_55:
    buffer_load_dwordx4 a[88:91], v3, s[32:35], s53 offen
    s_add_u32 s53, s53, s96
    buffer_load_dwordx4 a[92:95], v3, s[32:35], s54 offen
    s_add_u32 s54, s54, s96
    buffer_load_dwordx4 a[96:99], v3, s[32:35], s53 offen
    s_add_u32 s53, s53, 2048
    buffer_load_dwordx4 a[100:103], v3, s[32:35], s54 offen
    s_add_u32 s54, s54, 2048
    buffer_load_dwordx4 a[104:107], v3, s[32:35], s53 offen
    s_sub_u32 s53, s53, 43008
    buffer_load_dwordx4 a[108:111], v3, s[32:35], s54 offen
    s_sub_u32 s54, s54, 43008
    buffer_load_dwordx4 a[112:115], v3, s[32:35], s53 offen
    s_add_u32 s53, s53, 2048
    buffer_load_dwordx4 a[116:119], v3, s[32:35], s54 offen
    s_add_u32 s54, s54, 2048
    buffer_load_dwordx4 a[120:123], v3, s[32:35], s53 offen
    s_add_u32 s53, s53, s97
    buffer_load_dwordx4 a[124:127], v3, s[32:35], s54 offen
    s_add_u32 s54, s54, s97
    buffer_load_dwordx4 a[128:131], v3, s[32:35], s53 offen
    s_add_u32 s53, s53, 2048
    buffer_load_dwordx4 a[132:135], v3, s[32:35], s54 offen
    s_add_u32 s54, s54, 2048
    buffer_load_dwordx4 a[136:139], v3, s[32:35], s53 offen
    s_add_u32 s53, s53, s96
    buffer_load_dwordx4 a[140:143], v3, s[32:35], s54 offen
    s_add_u32 s54, s54, s96
    buffer_load_dwordx4 a[144:147], v3, s[32:35], s53 offen
    s_add_u32 s53, s53, 2048
    buffer_load_dwordx4 a[148:151], v3, s[32:35], s54 offen
    s_add_u32 s54, s54, 2048
    buffer_load_dwordx4 a[152:155], v3, s[32:35], s53 offen
    s_add_u32 s53, s53, s97
    buffer_load_dwordx4 a[156:159], v3, s[32:35], s54 offen
    s_add_u32 s54, s54, s97
    buffer_load_dwordx4 a[160:163], v3, s[32:35], s53 offen
    s_add_u32 s53, s53, 2048
    buffer_load_dwordx4 a[164:167], v3, s[32:35], s54 offen
    s_add_u32 s54, s54, 2048
    buffer_load_dwordx4 a[168:171], v3, s[32:35], s53 offen
    s_add_u32 s53, s53, s96
    buffer_load_dwordx4 a[172:175], v3, s[32:35], s54 offen
    s_add_u32 s54, s54, s96
    buffer_load_dwordx4 a[176:179], v3, s[32:35], s53 offen
    s_add_u32 s53, s53, 2048
    buffer_load_dwordx4 a[180:183], v3, s[32:35], s54 offen
    s_add_u32 s54, s54, 2048
    buffer_load_dwordx4 a[184:187], v3, s[32:35], s53 offen
    s_add_u32 s53, s53, s97
    buffer_load_dwordx4 a[188:191], v3, s[32:35], s54 offen
    s_add_u32 s54, s54, s97
    buffer_load_dwordx4 a[192:195], v3, s[32:35], s53 offen
    s_add_u32 s53, s53, 2048
    buffer_load_dwordx4 a[196:199], v3, s[32:35], s54 offen
    s_add_u32 s54, s54, 2048
    buffer_load_dwordx4 a[200:203], v3, s[32:35], s53 offen
    s_add_u32 s53, s53, s96
    buffer_load_dwordx4 a[204:207], v3, s[32:35], s54 offen
    s_add_u32 s54, s54, s96
    buffer_load_dwordx4 a[208:211], v3, s[32:35], s53 offen
    s_add_u32 s53, s53, 2048
    buffer_load_dwordx4 a[212:215], v3, s[32:35], s54 offen
    s_add_u32 s54, s54, 2048
    buffer_load_dwordx4 a[216:219], v3, s[32:35], s53 offen
    s_add_u32 s53, s53, s97
    buffer_load_dwordx4 a[220:223], v3, s[32:35], s54 offen
    s_add_u32 s54, s54, s97
P3D_56:
    s_waitcnt vmcnt(0)
    s_lshl_b32 s57, s43, 8
    s_lshl_b32 s58, s44, 4
    s_add_u32 s57, s57, s58
    s_lshl_b32 s58, s40, 2
    s_add_u32 s57, s57, s58
    s_add_u32 s57, s57, 200704
    v_mov_b32 v4, s57
    v_mov_b32 v5, s45
    s_cmp_eq_u32 s46, 1
    s_cbranch_scc1 F_65
    s_mov_b64 exec, 1
    buffer_store_dword v5, v4, s[32:35], 0 offen sc1
    s_mov_b64 exec, -1
    s_branch D_66
F_65:
    s_mov_b64 exec, 1
    buffer_store_dword v5, v4, s[32:35], 0 offen
    s_mov_b64 exec, -1
D_66:
    s_lshl_b32 s57, s43, 8
    s_add_u32 s57, s57, 200704
    v_lshlrev_b32 v4, 2, v0
    v_add_u32 v4, s57, v4
    s_mov_b32 s52, 400000
P_67:
    buffer_load_dword v5, v4, s[32:35], 0 offen sc1
    s_waitcnt vmcnt(0)
    v_and_b32 v6, 0xfffffff0, v5
    v_cmp_eq_u32 vcc, s45, v6
    s_cmp_eq_u64 vcc, -1
    s_cbranch_scc1 PD_68
    s_sub_u32 s52, s52, 1
    s_cmp_eq_u32 s52, 0
    s_cbranch_scc0 P_67
    v_mov_b32 v6, 3
    v_mov_b32 v7, 12
    buffer_store_dword v6, v7, s[36:39], 0 offen
PD_68:
    s_lshl_b32 s57, s50, 12
    s_add_u32 s57, s57, 3145728
    v_lshlrev_b32 v14, 4, v1
    v_lshl_add_u32 v14, v2, 11, v14
    buffer_load_dwordx4 v[240:243], v14, s[32:35], s57 offen offset:0
    buffer_load_dwordx4 v[244:247], v14, s[32:35], s57 offen offset:512
    buffer_load_dwordx4 v[248:251], v14, s[32:35], s57 offen offset:1024
    buffer_load_dwordx4 v[252:255], v14, s[32:35], s57 offen offset:1536
    s_lshr_b32 s57, s40, 1
    s_xor_b32 s57, s57, 0
    s_cmp_eq_u32 s57, 0
    s_cselect_b32 s57, s48, s49
    s_mul_i32 s57, s57, 114688
    s_mul_i32 s58, s40, 28672
    s_add_u32 s57, s57, s58
    s_add_u32 s60, s57, 16777216
    s_lshr_b32 s57, s40, 1
    s_xor_b32 s57, s57, 1
    s_cmp_eq_u32 s57, 0
    s_cselect_b32 s57, s48, s49
    s_mul_i32 s57, s57, 114688
    s_mul_i32 s58, s40, 28672
    s_add_u32 s57, s57, s58
    s_add_u32 s61, s57, 16777216
    buffer_load_dwordx4 v[176:179], v3, s[32:35], s61 offen offset:0
    buffer_load_dwordx4 v[180:183], v3, s[32:35], s61 offen offset:1024
    buffer_load_dwordx4 v[184:187], v3, s[32:35], s61 offen offset:2048
    buffer_load_dwordx4 v[188:191], v3, s[32:35], s61 offen offset:3072
    s_add_u32 s61, s61, 4096
    buffer_load_dwordx4 v[192:195], v3, s[32:35], s61 offen offset:0
    buffer_load_dwordx4 v[196:199], v3, s[32:35], s61 offen offset:1024
    buffer_load_dwordx4 v[200:203], v3, s[32:35], s61 offen offset:2048
    buffer_load_dwordx4 v[204:207], v3, s[32:35], s61 offen offset:3072
    s_add_u32 s61, s61, 4096
    buffer_load_dwordx4 v[208:211], v3, s[32:35], s61 offen offset:0
    buffer_load_dwordx4 v[212:215], v3, s[32:35], s61 offen offset:1024
    buffer_load_dwordx4 v[216:219], v3, s[32:35], s61 offen offset:2048
    buffer_load_dwordx4 v[220:223], v3, s[32:35], s61 offen offset:3072
    s_xor_b32 s57, s40, 0
    s_lshl_b32 s57, s57, 13
    s_add_u32 s57, s57, 131072
    v_add_u32 v4, s57, v3
    s_xor_b32 s57, s40, 2
    s_lshl_b32 s57, s57, 13
    s_add_u32 s57, s57, 131072
    v_add_u32 v5, s57, v3
    s_xor_b32 s57, s40, 3
    s_lshl_b32 s57, s57, 13
    s_add_u32 s57, s57, 131072
    v_add_u32 v6, s57, v3
    s_waitcnt vmcnt(11)
    v_mfma_f32_32x32x16_bf16 v[144:159], a[0:3], v[176:179], 0
    v_mfma_f32_32x32x16_bf16 v[160:175], a[4:7], v[176:179], 0
    v_pk_add_f32 v[240:241], v[240:241], v[242:243]
    v_pk_add_f32 v[244:245], v[244:245], v[246:247]
    v_pk_add_f32 v[248:249], v[248:249], v[250:251]
    v_pk_add_f32 v[252:253], v[252:253], v[254:255]
    v_pk_add_f32 v[240:241], v[240:241], v[244:245]
    v_pk_add_f32 v[248:249], v[248:249], v[252:253]
    v_pk_add_f32 v[240:241], v[240:241], v[248:249]
    v_mov_b32 v242, v240
    v_mov_b32 v243, v241
    s_nop 1
    v_permlane32_swap_b32 v240, v242
    v_permlane32_swap_b32 v241, v243
    s_nop 0
    v_pk_add_f32 v[240:241], v[240:241], v[242:243]
    v_mul_f32 v10, 0x3b000000, v240
    v_mul_f32 v241, 0x3b000000, v241
    v_fma_f32 v241, -v10, v10, v241
    v_max_f32 v241, 0, v241
    v_add_f32 v241, 0x3727c5ac, v241
    v_rsq_f32 v8, v241
    s_nop 0
    v_mov_b32 v9, v8
    s_add_u32 s61, s61, 4096
    buffer_load_dwordx4 v[176:179], v3, s[32:35], s61 offen offset:0
    s_waitcnt vmcnt(11)
    v_mfma_f32_32x32x16_bf16 v[144:159], a[8:11], v[180:183], v[144:159]
    v_mfma_f32_32x32x16_bf16 v[160:175], a[12:15], v[180:183], v[160:175]
    buffer_load_dwordx4 v[180:183], v3, s[32:35], s61 offen offset:1024
    s_waitcnt vmcnt(11)
    v_mfma_f32_32x32x16_bf16 v[144:159], a[16:19], v[184:187], v[144:159]
    v_mfma_f32_32x32x16_bf16 v[160:175], a[20:23], v[184:187], v[160:175]
    buffer_load_dwordx4 v[184:187], v3, s[32:35], s61 offen offset:2048
    s_waitcnt vmcnt(11)
    v_mfma_f32_32x32x16_bf16 v[144:159], a[24:27], v[188:191], v[144:159]
    v_mfma_f32_32x32x16_bf16 v[160:175], a[28:31], v[188:191], v[160:175]
    buffer_load_dwordx4 v[188:191], v3, s[32:35], s61 offen offset:3072
    s_waitcnt vmcnt(11)
    v_mfma_f32_32x32x16_bf16 v[144:159], a[32:35], v[192:195], v[144:159]
    v_mfma_f32_32x32x16_bf16 v[160:175], a[36:39], v[192:195], v[160:175]
    s_add_u32 s61, s61, 4096
    buffer_load_dwordx4 v[192:195], v3, s[32:35], s61 offen offset:0
    s_waitcnt vmcnt(11)
    v_mfma_f32_32x32x16_bf16 v[144:159], a[40:43], v[196:199], v[144:159]
    v_mfma_f32_32x32x16_bf16 v[160:175], a[44:47], v[196:199], v[160:175]
    buffer_load_dwordx4 v[196:199], v3, s[32:35], s61 offen offset:1024
    s_waitcnt vmcnt(11)
    v_mfma_f32_32x32x16_bf16 v[144:159], a[48:51], v[200:203], v[144:159]
    v_mfma_f32_32x32x16_bf16 v[160:175], a[52:55], v[200:203], v[160:175]
    buffer_load_dwordx4 v[200:203], v3, s[32:35], s61 offen offset:2048
    s_waitcnt vmcnt(11)
    v_mfma_f32_32x32x16_bf16 v[144:159], a[56:59], v[204:207], v[144:159]
    v_mfma_f32_32x32x16_bf16 v[160:175], a[60:63], v[204:207], v[160:175]
    buffer_load_dwordx4 v[204:207], v3, s[32:35], s61 offen offset:3072
    s_waitcnt vmcnt(11)
    v_mfma_f32_32x32x16_bf16 v[144:159], a[64:67], v[208:211], v[144:159]
    v_mfma_f32_32x32x16_bf16 v[160:175], a[68:71], v[208:211], v[160:175]
    s_add_u32 s61, s61, 4096
    buffer_load_dwordx4 v[208:211], v3, s[32:35], s61 offen offset:0
    s_waitcnt vmcnt(11)
    v_mfma_f32_32x32x16_bf16 v[144:159], a[72:75], v[212:215], v[144:159]
    v_mfma_f32_32x32x16_bf16 v[160:175], a[76:79], v[212:215], v[160:175]
    buffer_load_dwordx4 v[212:215], v3, s[32:35], s61 offen offset:1024
    s_waitcnt vmcnt(11)
    v_mfma_f32_32x32x16_bf16 v[144:159], a[80:83], v[216:219], v[144:159]
    v_mfma_f32_32x32x16_bf16 v[160:175], a[84:87], v[216:219], v[160:175]
    buffer_load_dwordx4 v[216:219], v3, s[32:35], s61 offen offset:2048
    s_waitcnt vmcnt(11)
    v_mfma_f32_32x32x16_bf16 v[144:159], a[88:91], v[220:223], v[144:159]
    v_mfma_f32_32x32x16_bf16 v[160:175], a[92:95], v[220:223], v[160:175]
    buffer_load_dwordx4 v[220:223], v3, s[32:35], s61 offen offset:3072
    s_waitcnt vmcnt(11)
    v_mfma_f32_32x32x16_bf16 v[144:159], a[96:99], v[176:179], v[144:159]
    v_mfma_f32_32x32x16_bf16 v[160:175], a[100:103], v[176:179], v[160:175]
    s_add_u32 s61, s61, 4096
    buffer_load_dwordx4 v[176:179], v3, s[32:35], s61 offen offset:0
    s_waitcnt vmcnt(11)
    v_mfma_f32_32x32x16_bf16 v[144:159], a[104:107], v[180:183], v[144:159]
    v_mfma_f32_32x32x16_bf16 v[160:175], a[108:111], v[180:183], v[160:175]
    buffer_load_dwordx4 v[180:183], v3, s[32:35], s61 offen offset:1024
    s_waitcnt vmcnt(11)
    v_mfma_f32_32x32x16_bf16 v[144:159], a[112:115], v[184:187], v[144:159]
    v_mfma_f32_32x32x16_bf16 v[160:175], a[116:119], v[184:187], v[160:175]
    buffer_load_dwordx4 v[184:187], v3, s[32:35], s61 offen offset:2048
    s_waitcnt vmcnt(11)
    v_mfma_f32_32x32x16_bf16 v[144:159], a[120:123], v[188:191], v[144:159]
    v_mfma_f32_32x32x16_bf16 v[160:175], a[124:127], v[188:191], v[160:175]
    buffer_load_dwordx4 v[188:191], v3, s[32:35], s61 offen offset:3072
    s_waitcnt vmcnt(11)
    v_mfma_f32_32x32x16_bf16 v[144:159], a[128:131], v[192:195], v[144:159]
    v_mfma_f32_32x32x16_bf16 v[160:175], a[132:135], v[192:195], v[160:175]
    buffer_load_dwordx4 v[192:195], v3, s[32:35], s60 offen offset:0
    s_waitcnt vmcnt(11)
    v_mfma_f32_32x32x16_bf16 v[144:159], a[136:139], v[196:199], v[144:159]
    v_mfma_f32_32x32x16_bf16 v[160:175], a[140:143], v[196:199], v[160:175]
    buffer_load_dwordx4 v[196:199], v3, s[32:35], s60 offen offset:1024
    s_waitcnt vmcnt(11)
    v_mfma_f32_32x32x16_bf16 v[144:159], a[144:147], v[200:203], v[144:159]
    v_mfma_f32_32x32x16_bf16 v[160:175], a[148:151], v[200:203], v[160:175]
    buffer_load_dwordx4 v[200:203], v3, s[32:35], s60 offen offset:2048
    s_waitcnt vmcnt(11)
    v_mfma_f32_32x32x16_bf16 v[144:159], a[152:155], v[204:207], v[144:159]
    v_mfma_f32_32x32x16_bf16 v[160:175], a[156:159], v[204:207], v[160:175]
    buffer_load_dwordx4 v[204:207], v3, s[32:35], s60 offen offset:3072
    s_waitcnt vmcnt(11)
    v_mfma_f32_32x32x16_bf16 v[144:159], a[160:163], v[208:211], v[144:159]
    v_mfma_f32_32x32x16_bf16 v[160:175], a[164:167], v[208:211], v[160:175]
    s_add_u32 s60, s60, 4096
    buffer_load_dwordx4 v[208:211], v3, s[32:35], s60 offen offset:0
    s_waitcnt vmcnt(11)
    v_mfma_f32_32x32x16_bf16 v[144:159], a[168:171], v[212:215], v[144:159]
    v_mfma_f32_32x32x16_bf16 v[160:175], a[172:175], v[212:215], v[160:175]
    buffer_load_dwordx4 v[212:215], v3, s[32:35], s60 offen offset:1024
    s_waitcnt vmcnt(11)
    v_mfma_f32_32x32x16_bf16 v[144:159], a[176:179], v[216:219], v[144:159]
    v_mfma_f32_32x32x16_bf16 v[160:175], a[180:183], v[216:219], v[160:175]
    buffer_load_dwordx4 v[216:219], v3, s[32:35], s60 offen offset:2048
    s_waitcnt vmcnt(11)
    v_mfma_f32_32x32x16_bf16 v[144:159], a[184:187], v[220:223], v[144:159]
    v_mfma_f32_32x32x16_bf16 v[160:175], a[188:191], v[220:223], v[160:175]
    buffer_load_dwordx4 v[220:223], v3, s[32:35], s60 offen offset:3072
    s_waitcnt vmcnt(11)
    v_mfma_f32_32x32x16_bf16 v[144:159], a[192:195], v[176:179], v[144:159]
    v_mfma_f32_32x32x16_bf16 v[160:175], a[196:199], v[176:179], v[160:175]
    s_add_u32 s60, s60, 4096
    buffer_load_dwordx4 v[176:179], v3, s[32:35], s60 offen offset:0
    s_waitcnt vmcnt(11)
    v_mfma_f32_32x32x16_bf16 v[144:159], a[200:203], v[180:183], v[144:159]
    v_mfma_f32_32x32x16_bf16 v[160:175], a[204:207], v[180:183], v[160:175]
    buffer_load_dwordx4 v[180:183], v3, s[32:35], s60 offen offset:1024
    s_waitcnt vmcnt(11)
    v_mfma_f32_32x32x16_bf16 v[144:159], a[208:211], v[184:187], v[144:159]
    v_mfma_f32_32x32x16_bf16 v[160:175], a[212:215], v[184:187], v[160:175]
    buffer_load_dwordx4 v[184:187], v3, s[32:35], s60 offen offset:2048
    s_waitcnt vmcnt(11)
    v_mfma_f32_32x32x16_bf16 v[144:159], a[216:219], v[188:191], v[144:159]
    v_mfma_f32_32x32x16_bf16 v[160:175], a[220:223], v[188:191], v[160:175]
    buffer_load_dwordx4 v[188:191], v3, s[32:35], s60 offen offset:3072
    s_waitcnt vmcnt(11)
    v_mfma_f32_32x32x16_bf16 v[112:127], a[0:3], v[192:195], 0
    v_mfma_f32_32x32x16_bf16 v[128:143], a[4:7], v[192:195], 0
    s_add_u32 s60, s60, 4096
    buffer_load_dwordx4 v[192:195], v3, s[32:35], s60 offen offset:0
    s_waitcnt vmcnt(11)
    v_mfma_f32_32x32x16_bf16 v[112:127], a[8:11], v[196:199], v[112:127]
    v_mfma_f32_32x32x16_bf16 v[128:143], a[12:15], v[196:199], v[128:143]
    buffer_load_dwordx4 v[196:199], v3, s[32:35], s60 offen offset:1024
    s_waitcnt vmcnt(11)
    v_mfma_f32_32x32x16_bf16 v[112:127], a[16:19], v[200:203], v[112:127]
    v_mfma_f32_32x32x16_bf16 v[128:143], a[20:23], v[200:203], v[128:143]
    buffer_load_dwordx4 v[200:203], v3, s[32:35], s60 offen offset:2048
    s_waitcnt vmcnt(11)
    v_mfma_f32_32x32x16_bf16 v[112:127], a[24:27], v[204:207], v[112:127]
    v_mfma_f32_32x32x16_bf16 v[128:143], a[28:31], v[204:207], v[128:143]
    buffer_load_dwordx4 v[204:207], v3, s[32:35], s60 offen offset:3072
    s_waitcnt vmcnt(11)
    v_mfma_f32_32x32x16_bf16 v[112:127], a[32:35], v[208:211], v[112:127]
    v_mfma_f32_32x32x16_bf16 v[128:143], a[36:39], v[208:211], v[128:143]
    ds_write_b128 v4, v[144:147] offset:0
    s_add_u32 s60, s60, 4096
    buffer_load_dwordx4 v[208:211], v3, s[32:35], s60 offen offset:0
    s_waitcnt vmcnt(11)
    v_mfma_f32_32x32x16_bf16 v[112:127], a[40:43], v[212:215], v[112:127]
    v_mfma_f32_32x32x16_bf16 v[128:143], a[44:47], v[212:215], v[128:143]
    ds_write_b128 v4, v[148:151] offset:1024
    buffer_load_dwordx4 v[212:215], v3, s[32:35], s60 offen offset:1024
    s_waitcnt vmcnt(11)
    v_mfma_f32_32x32x16_bf16 v[112:127], a[48:51], v[216:219], v[112:127]
    v_mfma_f32_32x32x16_bf16 v[128:143], a[52:55], v[216:219], v[128:143]
    ds_write_b128 v4, v[152:155] offset:2048
    buffer_load_dwordx4 v[216:219], v3, s[32:35], s60 offen offset:2048
    s_waitcnt vmcnt(11)
    v_mfma_f32_32x32x16_bf16 v[112:127], a[56:59], v[220:223], v[112:127]
    v_mfma_f32_32x32x16_bf16 v[128:143], a[60:63], v[220:223], v[128:143]
    ds_write_b128 v4, v[156:159] offset:3072
    buffer_load_dwordx4 v[220:223], v3, s[32:35], s60 offen offset:3072
    s_waitcnt vmcnt(11)
    v_mfma_f32_32x32x16_bf16 v[112:127], a[64:67], v[176:179], v[112:127]
    v_mfma_f32_32x32x16_bf16 v[128:143], a[68:71], v[176:179], v[128:143]
    ds_write_b128 v4, v[160:163] offset:4096
    s_add_u32 s60, s60, 4096
    buffer_load_dwordx4 v[176:179], v3, s[32:35], s60 offen offset:0
    s_waitcnt vmcnt(11)
    v_mfma_f32_32x32x16_bf16 v[112:127], a[72:75], v[180:183], v[112:127]
    v_mfma_f32_32x32x16_bf16 v[128:143], a[76:79], v[180:183], v[128:143]
    ds_write_b128 v4, v[164:167] offset:5120
    buffer_load_dwordx4 v[180:183], v3, s[32:35], s60 offen offset:1024
    s_waitcnt vmcnt(11)
    v_mfma_f32_32x32x16_bf16 v[112:127], a[80:83], v[184:187], v[112:127]
    v_mfma_f32_32x32x16_bf16 v[128:143], a[84:87], v[184:187], v[128:143]
    ds_write_b128 v4, v[168:171] offset:6144
    buffer_load_dwordx4 v[184:187], v3, s[32:35], s60 offen offset:2048
    s_waitcnt vmcnt(11)
    v_mfma_f32_32x32x16_bf16 v[112:127], a[88:91], v[188:191], v[112:127]
    v_mfma_f32_32x32x16_bf16 v[128:143], a[92:95], v[188:191], v[128:143]
    ds_write_b128 v4, v[172:175] offset:7168
    buffer_load_dwordx4 v[188:191], v3, s[32:35], s60 offen offset:3072
    s_waitcnt vmcnt(11)
    v_mfma_f32_32x32x16_bf16 v[112:127], a[96:99], v[192:195], v[112:127]
    v_mfma_f32_32x32x16_bf16 v[128:143], a[100:103], v[192:195], v[128:143]
    s_add_u32 s60, s60, 4096
    buffer_load_dwordx4 v[192:195], v3, s[32:35], s60 offen offset:0
    s_waitcnt vmcnt(11)
    v_mfma_f32_32x32x16_bf16 v[112:127], a[104:107], v[196:199], v[112:127]
    v_mfma_f32_32x32x16_bf16 v[128:143], a[108:111], v[196:199], v[128:143]
    buffer_load_dwordx4 v[196:199], v3, s[32:35], s60 offen offset:1024
    s_waitcnt vmcnt(11)
    v_mfma_f32_32x32x16_bf16 v[112:127], a[112:115], v[200:203], v[112:127]
    v_mfma_f32_32x32x16_bf16 v[128:143], a[116:119], v[200:203], v[128:143]
    s_waitcnt lgkmcnt(0)
    s_barrier
    buffer_load_dwordx4 v[200:203], v3, s[32:35], s60 offen offset:2048
    s_waitcnt vmcnt(11)
    v_mfma_f32_32x32x16_bf16 v[112:127], a[120:123], v[204:207], v[112:127]
    v_mfma_f32_32x32x16_bf16 v[128:143], a[124:127], v[204:207], v[128:143]
    ds_read_b128 v[240:243], v5 offset:4096
    buffer_load_dwordx4 v[204:207], v3, s[32:35], s60 offen offset:3072
    s_waitcnt vmcnt(11)
    v_mfma_f32_32x32x16_bf16 v[112:127], a[128:131], v[208:211], v[112:127]
    v_mfma_f32_32x32x16_bf16 v[128:143], a[132:135], v[208:211], v[128:143]
    ds_read_b128 v[244:247], v5 offset:5120
    s_waitcnt vmcnt(10)
    v_mfma_f32_32x32x16_bf16 v[112:127], a[136:139], v[212:215], v[112:127]
    v_mfma_f32_32x32x16_bf16 v[128:143], a[140:143], v[212:215], v[128:143]
    ds_read_b128 v[248:251], v5 offset:6144
    s_waitcnt vmcnt(9)
    v_mfma_f32_32x32x16_bf16 v[112:127], a[144:147], v[216:219], v[112:127]
    v_mfma_f32_32x32x16_bf16 v[128:143], a[148:151], v[216:219], v[128:143]
    ds_read_b128 v[252:255], v5 offset:7168
    s_waitcnt vmcnt(8)
    v_mfma_f32_32x32x16_bf16 v[112:127], a[152:155], v[220:223], v[112:127]
    v_mfma_f32_32x32x16_bf16 v[128:143], a[156:159], v[220:223], v[128:143]
    ds_read_b128 v[224:227], v5 offset:0
    s_waitcnt vmcnt(7)
    v_mfma_f32_32x32x16_bf16 v[112:127], a[160:163], v[176:179], v[112:127]
    v_mfma_f32_32x32x16_bf16 v[128:143], a[164:167], v[176:179], v[128:143]
    ds_read_b128 v[228:231], v5 offset:1024
    s_waitcnt vmcnt(6)
    v_mfma_f32_32x32x16_bf16 v[112:127], a[168:171], v[180:183], v[112:127]
    v_mfma_f32_32x32x16_bf16 v[128:143], a[172:175], v[180:183], v[128:143]
    ds_read_b128 v[232:235], v5 offset:2048
    s_waitcnt vmcnt(5)
    v_mfma_f32_32x32x16_bf16 v[112:127], a[176:179], v[184:187], v[112:127]
    v_mfma_f32_32x32x16_bf16 v[128:143], a[180:183], v[184:187], v[128:143]
    ds_read_b128 v[236:239], v5 offset:3072
    s_waitcnt vmcnt(4)
    v_mfma_f32_32x32x16_bf16 v[112:127], a[184:187], v[188:191], v[112:127]
    v_mfma_f32_32x32x16_bf16 v[128:143], a[188:191], v[188:191], v[128:143]
    s_waitcnt vmcnt(3)
    v_mfma_f32_32x32x16_bf16 v[112:127], a[192:195], v[192:195], v[112:127]
    v_mfma_f32_32x32x16_bf16 v[128:143], a[196:199], v[192:195], v[128:143]
    s_waitcnt vmcnt(2)
    v_mfma_f32_32x32x16_bf16 v[112:127], a[200:203], v[196:199], v[112:127]
    v_mfma_f32_32x32x16_bf16 v[128:143], a[204:207], v[196:199], v[128:143]
    s_waitcnt vmcnt(1)
    v_mfma_f32_32x32x16_bf16 v[112:127], a[208:211], v[200:203], v[112:127]
    v_mfma_f32_32x32x16_bf16 v[128:143], a[212:215], v[200:203], v[128:143]
    s_waitcnt vmcnt(0)
    v_mfma_f32_32x32x16_bf16 v[112:127], a[216:219], v[204:207], v[112:127]
    v_mfma_f32_32x32x16_bf16 v[128:143], a[220:223], v[204:207], v[128:143]
    v_lshlrev_b32 v176, 16, v16
    v_and_b32 v177, 0xffff0000, v16
    v_lshlrev_b32 v178, 16, v17
    v_and_b32 v179, 0xffff0000, v17
    v_lshlrev_b32 v180, 16, v18
    v_and_b32 v181, 0xffff0000, v18
    v_lshlrev_b32 v182, 16, v19
    v_and_b32 v183, 0xffff0000, v19
    v_lshlrev_b32 v184, 16, v20
    v_and_b32 v185, 0xffff0000, v20
    v_lshlrev_b32 v186, 16, v21
    v_and_b32 v187, 0xffff0000, v21
    v_lshlrev_b32 v188, 16, v22
    v_and_b32 v189, 0xffff0000, v22
    v_lshlrev_b32 v190, 16, v23
    v_and_b32 v191, 0xffff0000, v23
    s_waitcnt lgkmcnt(0)
    v_pk_add_f32 v[128:129], v[128:129], v[240:241]
    v_pk_add_f32 v[130:131], v[130:131], v[242:243]
    v_pk_add_f32 v[132:133], v[132:133], v[244:245]
    v_pk_add_f32 v[134:135], v[134:135], v[246:247]
    v_pk_add_f32 v[136:137], v[136:137], v[248:249]
    v_pk_add_f32 v[138:139], v[138:139], v[250:251]
    v_pk_add_f32 v[140:141], v[140:141], v[252:253]
    v_pk_add_f32 v[142:143], v[142:143], v[254:255]
    ds_write_b128 v5, v[128:131] offset:0
    ds_write_b128 v5, v[132:135] offset:1024
    ds_write_b128 v5, v[136:139] offset:2048
    ds_write_b128 v5, v[140:143] offset:3072
    v_pk_add_f32 v[112:113], v[112:113], v[224:225]
    v_pk_add_f32 v[114:115], v[114:115], v[226:227]
    v_pk_add_f32 v[116:117], v[116:117], v[228:229]
    v_pk_add_f32 v[118:119], v[118:119], v[230:231]
    v_pk_add_f32 v[120:121], v[120:121], v[232:233]
    v_pk_add_f32 v[122:123], v[122:123], v[234:235]
    v_pk_add_f32 v[124:125], v[124:125], v[236:237]
    v_pk_add_f32 v[126:127], v[126:127], v[238:239]
    s_waitcnt lgkmcnt(0)
    s_barrier
    ds_read_b128 v[192:195], v6 offset:0
    ds_read_b128 v[196:199], v6 offset:1024
    ds_read_b128 v[200:203], v6 offset:2048
    ds_read_b128 v[204:207], v6 offset:3072
    s_waitcnt lgkmcnt(3)
    v_pk_add_f32 v[112:113], v[112:113], v[192:193]
    v_pk_add_f32 v[114:115], v[114:115], v[194:195]
    s_waitcnt lgkmcnt(2)
    v_pk_add_f32 v[116:117], v[116:117], v[196:197]
    v_pk_add_f32 v[118:119], v[118:119], v[198:199]
    s_waitcnt lgkmcnt(1)
    v_pk_add_f32 v[120:121], v[120:121], v[200:201]
    v_pk_add_f32 v[122:123], v[122:123], v[202:203]
    s_waitcnt lgkmcnt(0)
    v_pk_add_f32 v[124:125], v[124:125], v[204:205]
    v_pk_add_f32 v[126:127], v[126:127], v[206:207]
    v_pk_fma_f32 v[112:113], v[112:113], v[8:9], v[176:177]
    v_pk_fma_f32 v[114:115], v[114:115], v[8:9], v[178:179]
    v_pk_fma_f32 v[116:117], v[116:117], v[8:9], v[180:181]
    v_pk_fma_f32 v[118:119], v[118:119], v[8:9], v[182:183]
    v_pk_fma_f32 v[120:121], v[120:121], v[8:9], v[184:185]
    v_pk_fma_f32 v[122:123], v[122:123], v[8:9], v[186:187]
    v_pk_fma_f32 v[124:125], v[124:125], v[8:9], v[188:189]
    v_pk_fma_f32 v[126:127], v[126:127], v[8:9], v[190:191]
    v_cvt_pk_bf16_f32 v16, v112, v113
    v_cvt_pk_bf16_f32 v17, v114, v115
    v_cvt_pk_bf16_f32 v18, v116, v117
    v_cvt_pk_bf16_f32 v19, v118, v119
    v_cvt_pk_bf16_f32 v20, v120, v121
    v_cvt_pk_bf16_f32 v21, v122, v123
    v_cvt_pk_bf16_f32 v22, v124, v125
    v_cvt_pk_bf16_f32 v23, v126, v127
    s_lshl_b32 s60, s50, 15
    s_lshl_b32 s57, s42, 11
    s_add_u32 s60, s60, s57
    s_and_b32 s57, s40, 1
    s_lshl_b32 s57, s57, 14
    s_add_u32 s60, s60, s57
    s_add_u32 s60, s60, 8388608
    s_add_u32 s60, s60, s55
    s_cmp_eq_u32 s46, 1
    s_cbranch_scc1 F_69
    buffer_store_dwordx4 v[16:19], v3, s[32:35], s60 offen offset:0 sc1
    buffer_store_dwordx4 v[20:23], v3, s[32:35], s60 offen offset:1024 sc1
    s_branch D_70
F_69:
    buffer_store_dwordx4 v[16:19], v3, s[32:35], s60 offen offset:0
    buffer_store_dwordx4 v[20:23], v3, s[32:35], s60 offen offset:1024
D_70:
    v_pk_add_f32 v[8:9], v[112:113], v[114:115]
    v_pk_mul_f32 v[10:11], v[112:113], v[112:113]
    v_pk_fma_f32 v[10:11], v[114:115], v[114:115], v[10:11]
    v_pk_add_f32 v[8:9], v[8:9], v[116:117]
    v_pk_fma_f32 v[10:11], v[116:117], v[116:117], v[10:11]
    v_pk_add_f32 v[8:9], v[8:9], v[118:119]
    v_pk_fma_f32 v[10:11], v[118:119], v[118:119], v[10:11]
    v_pk_add_f32 v[8:9], v[8:9], v[120:121]
    v_pk_fma_f32 v[10:11], v[120:121], v[120:121], v[10:11]
    v_pk_add_f32 v[8:9], v[8:9], v[122:123]
    v_pk_fma_f32 v[10:11], v[122:123], v[122:123], v[10:11]
    v_pk_add_f32 v[8:9], v[8:9], v[124:125]
    v_pk_fma_f32 v[10:11], v[124:125], v[124:125], v[10:11]
    v_pk_add_f32 v[8:9], v[8:9], v[126:127]
    v_pk_fma_f32 v[10:11], v[126:127], v[126:127], v[10:11]
    v_add_f32 v8, v8, v9
    v_add_f32 v9, v10, v11
    v_mov_b32 v10, v8
    v_mov_b32 v11, v9
    s_lshl_b32 s57, s50, 12
    s_lshl_b32 s58, s42, 9
    s_add_u32 s57, s57, s58
    s_and_b32 s58, s40, 1
    s_lshl_b32 s58, s58, 3
    s_add_u32 s57, s57, s58
    s_add_u32 s59, s57, 3407872
    v_permlane32_swap_b32 v8, v10
    v_permlane32_swap_b32 v9, v11
    v_lshlrev_b32 v12, 4, v1
    s_nop 0
    v_pk_add_f32 v[8:9], v[8:9], v[10:11]
    s_cmp_eq_u32 s46, 1
    s_cbranch_scc1 F_71
    buffer_store_dwordx2 v[8:9], v12, s[32:35], s59 offen sc1
    s_branch D_72
F_71:
    buffer_store_dwordx2 v[8:9], v12, s[32:35], s59 offen
D_72:
    s_waitcnt vmcnt(0)
    s_lshl_b32 s57, s43, 8
    s_lshl_b32 s58, s44, 4
    s_add_u32 s57, s57, s58
    s_lshl_b32 s58, s40, 2
    s_add_u32 s57, s57, s58
    s_add_u32 s57, s57, 204800
    v_mov_b32 v4, s57
    v_mov_b32 v5, s45
    s_cmp_eq_u32 s46, 1
    s_cbranch_scc1 F_73
    s_mov_b64 exec, 1
    buffer_store_dword v5, v4, s[32:35], 0 offen sc1
    s_mov_b64 exec, -1
    s_branch D_74
F_73:
    s_mov_b64 exec, 1
    buffer_store_dword v5, v4, s[32:35], 0 offen
    s_mov_b64 exec, -1
D_74:
    v_and_b32 v4, 1, v1
    v_mul_u32_u24 v4, 0x8000, v4
    v_lshl_or_b32 v5, v4, 16, v4
    s_cmp_ge_u32 s40, 2
    s_cselect_b32 s57, -1, 0
    v_and_b32 v5, s57, v5
    s_and_b32 s58, s57, 0x80008000
    v_xor_b32 v6, s58, v5
    s_bitcmp1_b32 s40, 0
    s_cselect_b64 vcc, -1, 0
    v_cndmask_b32 v7, v5, v6, vcc
    v_cndmask_b32 v8, v6, v5, vcc
    v_xor_b32 v40, v7, v40
    v_xor_b32 v41, v7, v41
    v_xor_b32 v42, v7, v42
    v_xor_b32 v43, v7, v43
    v_xor_b32 v44, v7, v44
    v_xor_b32 v45, v7, v45
    v_xor_b32 v46, v7, v46
    v_xor_b32 v47, v7, v47
    v_xor_b32 v48, v7, v48
    v_xor_b32 v49, v7, v49
    v_xor_b32 v50, v7, v50
    v_xor_b32 v51, v7, v51
    v_xor_b32 v52, v7, v52
    v_xor_b32 v53, v7, v53
    v_xor_b32 v54, v7, v54
    v_xor_b32 v55, v7, v55
    v_xor_b32 v56, v7, v56
    v_xor_b32 v57, v7, v57
    v_xor_b32 v58, v7, v58
    v_xor_b32 v59, v7, v59
    v_xor_b32 v60, v7, v60
    v_xor_b32 v61, v7, v61
    v_xor_b32 v62, v7, v62
    v_xor_b32 v63, v7, v63
    v_xor_b32 v64, v7, v64
    v_xor_b32 v65, v7, v65
    v_xor_b32 v66, v7, v66
    v_xor_b32 v67, v7, v67
    v_xor_b32 v68, v7, v68
    v_xor_b32 v69, v7, v69
    v_xor_b32 v70, v7, v70
    v_xor_b32 v71, v7, v71
    v_xor_b32 v72, v8, v72
    v_xor_b32 v73, v8, v73
    v_xor_b32 v74, v8, v74
    v_xor_b32 v75, v8, v75
    v_xor_b32 v76, v8, v76
    v_xor_b32 v77, v8, v77
    v_xor_b32 v78, v8, v78
    v_xor_b32 v79, v8, v79
    v_xor_b32 v80, v8, v80
    v_xor_b32 v81, v8, v81
    v_xor_b32 v82, v8, v82
    v_xor_b32 v83, v8, v83
    v_xor_b32 v84, v8, v84
    v_xor_b32 v85, v8, v85
    v_xor_b32 v86, v8, v86
    v_xor_b32 v87, v8, v87
    v_xor_b32 v88, v8, v88
    v_xor_b32 v89, v8, v89
    v_xor_b32 v90, v8, v90
    v_xor_b32 v91, v8, v91
    v_xor_b32 v92, v8, v92
    v_xor_b32 v93, v8, v93
    v_xor_b32 v94, v8, v94
    v_xor_b32 v95, v8, v95
    v_xor_b32 v96, v8, v96
    v_xor_b32 v97, v8, v97
    v_xor_b32 v98, v8, v98
    v_xor_b32 v99, v8, v99
    v_xor_b32 v100, v8, v100
    v_xor_b32 v101, v8, v101
    v_xor_b32 v102, v8, v102
    v_xor_b32 v103, v8, v103
    v_cmp_gt_u32 vcc, 32, v0
    s_cmp_eq_u32 s40, 2
    s_cselect_b64 s[64:65], -1, 0
    s_and_b64 vcc, vcc, s[64:65]
    v_cndmask_b32 v4, 0, v4, vcc
    v_xor_b32 v40, v4, v40
    s_lshl_b32 s57, s43, 8
    s_add_u32 s57, s57, 204800
    v_lshlrev_b32 v4, 2, v0
    v_add_u32 v4, s57, v4
    s_mov_b32 s52, 400000
P_75:
    buffer_load_dword v5, v4, s[32:35], 0 offen sc1
    s_waitcnt vmcnt(0)
    v_and_b32 v6, 0xfffffff0, v5
    v_cmp_eq_u32 vcc, s45, v6
    s_cmp_eq_u64 vcc, -1
    s_cbranch_scc1 PD_76
    s_sub_u32 s52, s52, 1
    s_cmp_eq_u32 s52, 0
    s_cbranch_scc0 P_75
    v_mov_b32 v6, 4
    v_mov_b32 v7, 16
    buffer_store_dword v6, v7, s[36:39], 0 offen
PD_76:
    s_lshr_b32 s62, s40, 1
    s_lshl_b32 s62, s62, 5
    s_add_u32 s62, s62, s41
    s_lshl_b32 s57, s62, 12
    s_add_u32 s57, s57, 3407872
    v_lshlrev_b32 v14, 4, v1
    v_lshl_add_u32 v14, v2, 11, v14
    buffer_load_dwordx4 v[240:243], v14, s[32:35], s57 offen offset:0
    buffer_load_dwordx4 v[244:247], v14, s[32:35], s57 offen offset:512
    buffer_load_dwordx4 v[248:251], v14, s[32:35], s57 offen offset:1024
    buffer_load_dwordx4 v[252:255], v14, s[32:35], s57 offen offset:1536
    s_lshr_b32 s57, s40, 1
    s_xor_b32 s57, s57, 0
    s_lshl_b32 s57, s57, 5
    s_add_u32 s57, s57, s41
    s_lshl_b32 s57, s57, 15
    s_lshl_b32 s58, s40, 13
    s_add_u32 s57, s57, s58
    s_add_u32 s60, s57, 8388608
    s_add_u32 s60, s60, s55
    s_lshr_b32 s57, s40, 1
    s_xor_b32 s57, s57, 1
    s_lshl_b32 s57, s57, 5
    s_add_u32 s57, s57, s41
    s_lshl_b32 s57, s57, 15
    s_lshl_b32 s58, s40, 13
    s_add_u32 s57, s57, s58
    s_add_u32 s61, s57, 8388608
    s_add_u32 s61, s61, s55
    buffer_load_dwordx4 v[208:211], v3, s[32:35], s61 offen offset:0 sc1
    buffer_load_dwordx4 v[212:215], v3, s[32:35], s61 offen offset:1024 sc1
    buffer_load_dwordx4 v[216:219], v3, s[32:35], s61 offen offset:2048 sc1
    buffer_load_dwordx4 v[220:223], v3, s[32:35], s61 offen offset:3072 sc1
    s_add_u32 s61, s61, 4096
    buffer_load_dwordx4 v[224:227], v3, s[32:35], s61 offen offset:0 sc1
    buffer_load_dwordx4 v[228:231], v3, s[32:35], s61 offen offset:1024 sc1
    buffer_load_dwordx4 v[232:235], v3, s[32:35], s61 offen offset:2048 sc1
    buffer_load_dwordx4 v[236:239], v3, s[32:35], s61 offen offset:3072 sc1
    buffer_load_dwordx4 v[176:179], v3, s[32:35], s60 offen offset:0 sc1
    buffer_load_dwordx4 v[180:183], v3, s[32:35], s60 offen offset:1024 sc1
    buffer_load_dwordx4 v[184:187], v3, s[32:35], s60 offen offset:2048 sc1
    buffer_load_dwordx4 v[188:191], v3, s[32:35], s60 offen offset:3072 sc1
    s_add_u32 s60, s60, 4096
    buffer_load_dwordx4 v[192:195], v3, s[32:35], s60 offen offset:0 sc1
    buffer_load_dwordx4 v[196:199], v3, s[32:35], s60 offen offset:1024 sc1
    buffer_load_dwordx4 v[200:203], v3, s[32:35], s60 offen offset:2048 sc1
    buffer_load_dwordx4 v[204:207], v3, s[32:35], s60 offen offset:3072 sc1
    s_xor_b32 s57, s40, 0
    s_lshl_b32 s57, s57, 13
    s_add_u32 s57, s57, 131072
    v_add_u32 v4, s57, v3
    s_xor_b32 s57, s40, 2
    s_lshl_b32 s57, s57, 13
    s_add_u32 s57, s57, 131072
    v_add_u32 v5, s57, v3
    s_xor_b32 s57, s40, 3
    s_lshl_b32 s57, s57, 13
    s_add_u32 s57, s57, 131072
    v_add_u32 v6, s57, v3
    s_waitcnt vmcnt(15)
    v_mfma_f32_32x32x16_bf16 v[144:159], v[208:211], v[40:43], 0
    v_mfma_f32_32x32x16_bf16 v[160:175], v[208:211], v[72:75], 0
    s_waitcnt vmcnt(14)
    v_mfma_f32_32x32x16_bf16 v[144:159], v[212:215], v[44:47], v[144:159]
    v_mfma_f32_32x32x16_bf16 v[160:175], v[212:215], v[76:79], v[160:175]
    v_pk_add_f32 v[240:241], v[240:241], v[242:243]
    v_pk_add_f32 v[244:245], v[244:245], v[246:247]
    v_pk_add_f32 v[248:249], v[248:249], v[250:251]
    v_pk_add_f32 v[252:253], v[252:253], v[254:255]
    v_pk_add_f32 v[240:241], v[240:241], v[244:245]
    v_pk_add_f32 v[248:249], v[248:249], v[252:253]
    v_pk_add_f32 v[240:241], v[240:241], v[248:249]
    v_mov_b32 v242, v240
    v_mov_b32 v243, v241
    s_nop 1
    v_permlane32_swap_b32 v240, v242
    v_permlane32_swap_b32 v241, v243
    s_nop 0
    v_pk_add_f32 v[240:241], v[240:241], v[242:243]
    v_mul_f32 v8, 0x3b000000, v240
    v_mul_f32 v241, 0x3b000000, v241
    v_fma_f32 v241, -v8, v8, v241
    v_max_f32 v241, 0, v241
    v_add_f32 v241, 0x3727c5ac, v241
    v_rsq_f32 v9, v241
    s_nop 0
    s_lshl_b32 s57, s40, 13
    s_add_u32 s57, s57, 131072
    v_lshlrev_b32 v12, 2, v1
    v_add_u32 v12, s57, v12
    v_lshlrev_b32 v13, 4, v2
    v_add_u32 v13, s57, v13
    ds_write_b32 v12, v9
    s_waitcnt vmcnt(13)
    v_mfma_f32_32x32x16_bf16 v[144:159], v[216:219], v[48:51], v[144:159]
    v_mfma_f32_32x32x16_bf16 v[160:175], v[216:219], v[80:83], v[160:175]
    s_waitcnt vmcnt(12)
    v_mfma_f32_32x32x16_bf16 v[144:159], v[220:223], v[52:55], v[144:159]
    v_mfma_f32_32x32x16_bf16 v[160:175], v[220:223], v[84:87], v[160:175]
    s_waitcnt vmcnt(11)
    v_mfma_f32_32x32x16_bf16 v[144:159], v[224:227], v[56:59], v[144:159]
    v_mfma_f32_32x32x16_bf16 v[160:175], v[224:227], v[88:91], v[160:175]
    s_waitcnt lgkmcnt(0)
    ds_read_b128 v[240:243], v13 offset:0
    ds_read_b128 v[244:247], v13 offset:32
    ds_read_b128 v[248:251], v13 offset:64
    ds_read_b128 v[252:255], v13 offset:96
    s_waitcnt vmcnt(10)
    v_mfma_f32_32x32x16_bf16 v[144:159], v[228:231], v[60:63], v[144:159]
    v_mfma_f32_32x32x16_bf16 v[160:175], v[228:231], v[92:95], v[160:175]
    s_waitcnt vmcnt(9)
    v_mfma_f32_32x32x16_bf16 v[144:159], v[232:235], v[64:67], v[144:159]
    v_mfma_f32_32x32x16_bf16 v[160:175], v[232:235], v[96:99], v[160:175]
    s_waitcnt vmcnt(8)
    v_mfma_f32_32x32x16_bf16 v[144:159], v[236:239], v[68:71], v[144:159]
    v_mfma_f32_32x32x16_bf16 v[160:175], v[236:239], v[100:103], v[160:175]
    s_waitcnt vmcnt(7)
    v_mfma_f32_32x32x16_bf16 v[112:127], v[176:179], v[40:43], 0
    v_mfma_f32_32x32x16_bf16 v[128:143], v[176:179], v[72:75], 0
    s_waitcnt vmcnt(6)
    v_mfma_f32_32x32x16_bf16 v[112:127], v[180:183], v[44:47], v[112:127]
    v_mfma_f32_32x32x16_bf16 v[128:143], v[180:183], v[76:79], v[128:143]
    s_waitcnt vmcnt(5)
    v_mfma_f32_32x32x16_bf16 v[112:127], v[184:187], v[48:51], v[112:127]
    ds_write_b128 v4, v[144:147] offset:0
    v_mfma_f32_32x32x16_bf16 v[128:143], v[184:187], v[80:83], v[128:143]
    ds_write_b128 v4, v[148:151] offset:1024
    s_waitcnt vmcnt(4)
    v_mfma_f32_32x32x16_bf16 v[112:127], v[188:191], v[52:55], v[112:127]
    ds_write_b128 v4, v[152:155] offset:2048
    v_mfma_f32_32x32x16_bf16 v[128:143], v[188:191], v[84:87], v[128:143]
    ds_write_b128 v4, v[156:159] offset:3072
    s_waitcnt vmcnt(3)
    v_mfma_f32_32x32x16_bf16 v[112:127], v[192:195], v[56:59], v[112:127]
    ds_write_b128 v4, v[160:163] offset:4096
    v_mfma_f32_32x32x16_bf16 v[128:143], v[192:195], v[88:91], v[128:143]
    ds_write_b128 v4, v[164:167] offset:5120
    s_waitcnt vmcnt(2)
    v_mfma_f32_32x32x16_bf16 v[112:127], v[196:199], v[60:63], v[112:127]
    ds_write_b128 v4, v[168:171] offset:6144
    v_mfma_f32_32x32x16_bf16 v[128:143], v[196:199], v[92:95], v[128:143]
    ds_write_b128 v4, v[172:175] offset:7168
    s_waitcnt vmcnt(1)
    v_mfma_f32_32x32x16_bf16 v[112:127], v[200:203], v[64:67], v[112:127]
    v_mfma_f32_32x32x16_bf16 v[128:143], v[200:203], v[96:99], v[128:143]
    s_waitcnt vmcnt(0)
    v_mfma_f32_32x32x16_bf16 v[112:127], v[204:207], v[68:71], v[112:127]
    v_mfma_f32_32x32x16_bf16 v[128:143], v[204:207], v[100:103], v[128:143]
    s_waitcnt lgkmcnt(0)
    s_barrier
    ds_read_b128 v[192:195], v5 offset:4096
    ds_read_b128 v[196:199], v5 offset:5120
    ds_read_b128 v[200:203], v5 offset:6144
    ds_read_b128 v[204:207], v5 offset:7168
    ds_read_b128 v[176:179], v5 offset:0
    ds_read_b128 v[180:183], v5 offset:1024
    ds_read_b128 v[184:187], v5 offset:2048
    ds_read_b128 v[188:191], v5 offset:3072
    s_nop 3
    s_waitcnt lgkmcnt(4)
    v_pk_add_f32 v[128:129], v[128:129], v[192:193]
    v_pk_add_f32 v[130:131], v[130:131], v[194:195]
    v_pk_add_f32 v[132:133], v[132:133], v[196:197]
    v_pk_add_f32 v[134:135], v[134:135], v[198:199]
    v_pk_add_f32 v[136:137], v[136:137], v[200:201]
    v_pk_add_f32 v[138:139], v[138:139], v[202:203]
    v_pk_add_f32 v[140:141], v[140:141], v[204:205]
    v_pk_add_f32 v[142:143], v[142:143], v[206:207]
    s_waitcnt lgkmcnt(0)
    ds_write_b128 v5, v[128:131] offset:0
    ds_write_b128 v5, v[132:135] offset:1024
    ds_write_b128 v5, v[136:139] offset:2048
    ds_write_b128 v5, v[140:143] offset:3072
    v_pk_add_f32 v[112:113], v[112:113], v[176:177]
    v_pk_add_f32 v[114:115], v[114:115], v[178:179]
    v_pk_add_f32 v[116:117], v[116:117], v[180:181]
    v_pk_add_f32 v[118:119], v[118:119], v[182:183]
    v_pk_add_f32 v[120:121], v[120:121], v[184:185]
    v_pk_add_f32 v[122:123], v[122:123], v[186:187]
    v_pk_add_f32 v[124:125], v[124:125], v[188:189]
    v_pk_add_f32 v[126:127], v[126:127], v[190:191]
    s_waitcnt lgkmcnt(0)
    s_barrier
    ds_read_b128 v[176:179], v6 offset:0
    ds_read_b128 v[180:183], v6 offset:1024
    ds_read_b128 v[184:187], v6 offset:2048
    ds_read_b128 v[188:191], v6 offset:3072
    s_waitcnt lgkmcnt(3)
    v_pk_add_f32 v[112:113], v[112:113], v[176:177]
    v_pk_add_f32 v[114:115], v[114:115], v[178:179]
    s_waitcnt lgkmcnt(2)
    v_pk_add_f32 v[116:117], v[116:117], v[180:181]
    v_pk_add_f32 v[118:119], v[118:119], v[182:183]
    s_waitcnt lgkmcnt(1)
    v_pk_add_f32 v[120:121], v[120:121], v[184:185]
    v_pk_add_f32 v[122:123], v[122:123], v[186:187]
    s_waitcnt lgkmcnt(0)
    v_pk_add_f32 v[124:125], v[124:125], v[188:189]
    v_pk_add_f32 v[126:127], v[126:127], v[190:191]
    v_pk_mul_f32 v[112:113], v[112:113], v[240:241]
    v_pk_mul_f32 v[114:115], v[114:115], v[242:243]
    v_pk_mul_f32 v[116:117], v[116:117], v[244:245]
    v_pk_mul_f32 v[118:119], v[118:119], v[246:247]
    v_pk_mul_f32 v[120:121], v[120:121], v[248:249]
    v_pk_mul_f32 v[122:123], v[122:123], v[250:251]
    v_pk_mul_f32 v[124:125], v[124:125], v[252:253]
    v_pk_mul_f32 v[126:127], v[126:127], v[254:255]
    v_cvt_pk_bf16_f32 v176, v112, v113
    v_cvt_pk_bf16_f32 v177, v114, v115
    v_cvt_pk_bf16_f32 v178, v116, v117
    v_cvt_pk_bf16_f32 v179, v118, v119
    v_cvt_pk_bf16_f32 v180, v120, v121
    v_cvt_pk_bf16_f32 v181, v122, v123
    v_cvt_pk_bf16_f32 v182, v124, v125
    v_cvt_pk_bf16_f32 v183, v126, v127
    s_lshl_b32 s57, s40, 13
    s_add_u32 s57, s57, 135168
    v_add_u32 v4, s57, v3
    s_xor_b32 s57, s40, 2
    s_lshl_b32 s57, s57, 13
    s_add_u32 s57, s57, 135168
    v_add_u32 v5, s57, v3
    ds_write_b128 v4, v[176:179]
    ds_write_b128 v4, v[180:183] offset:1024
    s_waitcnt lgkmcnt(0)
    s_barrier
    ds_read_b128 v[184:187], v5
    ds_read_b128 v[188:191], v5 offset:1024
    v_mfma_f32_32x32x16_bf16 v[112:127], v[24:27], v[176:179], 0
    v_mfma_f32_32x32x16_bf16 v[112:127], v[28:31], v[180:183], v[112:127]
    v_lshlrev_b32 v4, 17, v2
    v_lshl_add_u32 v4, v1, 2, v4
    s_waitcnt lgkmcnt(0)
    v_mfma_f32_32x32x16_bf16 v[112:127], v[32:35], v[184:187], v[112:127]
    v_mfma_f32_32x32x16_bf16 v[112:127], v[36:39], v[188:191], v[112:127]
    s_lshr_b32 s57, s40, 1
    s_lshl_b32 s57, s57, 20
    s_lshl_b32 s58, s42, 13
    s_add_u32 s57, s57, s58
    s_lshl_b32 s58, s41, 8
    s_add_u32 s57, s57, s58
    s_and_b32 s58, s40, 1
    s_lshl_b32 s58, s58, 7
    s_add_u32 s57, s57, s58
    s_add_u32 s57, s57, 6291456
    s_nop 7
    s_nop 1
    v_cvt_pk_bf16_f32 v176, v112, v113
    v_cvt_pk_bf16_f32 v177, v114, v115
    v_cvt_pk_bf16_f32 v178, v116, v117
    v_cvt_pk_bf16_f32 v179, v118, v119
    v_cvt_pk_bf16_f32 v180, v120, v121
    v_cvt_pk_bf16_f32 v181, v122, v123
    v_cvt_pk_bf16_f32 v182, v124, v125
    v_cvt_pk_bf16_f32 v183, v126, v127
    s_add_u32 s58, s57, 0
    buffer_store_dword v176, v4, s[32:35], s58 offen sc1
    s_add_u32 s58, s57, 65536
    buffer_store_dword v177, v4, s[32:35], s58 offen sc1
    s_add_u32 s58, s57, 262144
    buffer_store_dword v178, v4, s[32:35], s58 offen sc1
    s_add_u32 s58, s57, 327680
    buffer_store_dword v179, v4, s[32:35], s58 offen sc1
    s_add_u32 s58, s57, 524288
    buffer_store_dword v180, v4, s[32:35], s58 offen sc1
    s_add_u32 s58, s57, 589824
    buffer_store_dword v181, v4, s[32:35], s58 offen sc1
    s_add_u32 s58, s57, 786432
    buffer_store_dword v182, v4, s[32:35], s58 offen sc1
    s_add_u32 s58, s57, 851968
    buffer_store_dword v183, v4, s[32:35], s58 offen sc1
    s_waitcnt vmcnt(0)
    s_barrier
    s_lshl_b32 s57, s42, 5
    s_add_u32 s57, s57, s41
    s_lshl_b32 s57, s57, 7
    s_add_u32 s57, s57, 98304
    s_or_b32 s58, s45, s47
    v_mov_b32 v4, s57
    v_mov_b32 v5, s58
    s_cmp_eq_u32 s40, 0
    s_cbranch_scc0 NF_77
    s_mov_b64 exec, 1
    buffer_store_dword v5, v4, s[32:35], 0 offen sc1
    s_mov_b64 exec, -1
NF_77:
    s_cmp_eq_u32 s40, 0
    s_cbranch_scc0 PW_78
    s_lshl_b32 s57, s42, 5
    v_add_u32 v4, s57, v1
    v_lshlrev_b32 v4, 7, v4
    v_add_u32 v4, 98304, v4
    s_mov_b32 s52, 400000
P_79:
    buffer_load_dword v5, v4, s[32:35], 0 offen sc1
    s_waitcnt vmcnt(0)
    v_and_b32 v6, 0xfffffff0, v5
    v_cmp_eq_u32 vcc, s45, v6
    s_cmp_eq_u64 vcc, -1
    s_cbranch_scc1 PD_80
    s_sub_u32 s52, s52, 1
    s_cmp_eq_u32 s52, 0
    s_cbranch_scc0 P_79
    v_mov_b32 v6, 5
    v_mov_b32 v7, 20
    buffer_store_dword v6, v7, s[36:39], 0 offen
PD_80:
PW_78:
    s_waitcnt lgkmcnt(0)
    s_barrier
    s_lshl_b32 s57, s41, 16
    s_lshl_b32 s58, s42, 13
    s_add_u32 s57, s57, s58
    s_lshl_b32 s58, s40, 11
    s_add_u32 s57, s57, s58
    s_add_u32 s57, s57, 6291456
    s_add_u32 s58, s58, 131072
    s_add_u32 m0, s58, 0
    s_nop 0
    buffer_load_dwordx4 v3, s[32:35], s57 offen lds
    s_add_u32 s57, s57, 1024
    s_add_u32 m0, s58, 1024
    s_nop 0
    buffer_load_dwordx4 v3, s[32:35], s57 offen lds
    s_add_u32 s57, s57, 1024
    v_lshlrev_b32 v112, 16, v16
    v_and_b32 v113, 0xffff0000, v16
    v_lshlrev_b32 v114, 16, v17
    v_and_b32 v115, 0xffff0000, v17
    v_lshlrev_b32 v116, 16, v18
    v_and_b32 v117, 0xffff0000, v18
    v_lshlrev_b32 v118, 16, v19
    v_and_b32 v119, 0xffff0000, v19
    v_lshlrev_b32 v120, 16, v20
    v_and_b32 v121, 0xffff0000, v20
    v_lshlrev_b32 v122, 16, v21
    v_and_b32 v123, 0xffff0000, v21
    v_lshlrev_b32 v124, 16, v22
    v_and_b32 v125, 0xffff0000, v22
    v_lshlrev_b32 v126, 16, v23
    v_and_b32 v127, 0xffff0000, v23
    v_mov_b32 v8, v112
    v_lshlrev_b32 v4, 10, v2
    v_lshl_add_u32 v4, v1, 2, v4
    v_add_u32 v4, 131072, v4
    s_waitcnt vmcnt(0)
    s_barrier
    ds_read_b32 v176, v4 offset:0
    ds_read_b32 v177, v4 offset:256
    ds_read_b32 v178, v4 offset:512
    ds_read_b32 v179, v4 offset:768
    ds_read_b32 v180, v4 offset:2048
    ds_read_b32 v181, v4 offset:2304
    ds_read_b32 v182, v4 offset:2560
    ds_read_b32 v183, v4 offset:2816
    s_waitcnt lgkmcnt(0)
    ds_read_b32 v184, v4 offset:4096
    ds_read_b32 v185, v4 offset:4352
    ds_read_b32 v186, v4 offset:4608
    ds_read_b32 v187, v4 offset:4864
    ds_read_b32 v188, v4 offset:6144
    ds_read_b32 v189, v4 offset:6400
    ds_read_b32 v190, v4 offset:6656
    ds_read_b32 v191, v4 offset:6912
    s_waitcnt lgkmcnt(0)
    ds_read_b32 v192, v4 offset:128
    ds_read_b32 v193, v4 offset:384
    ds_read_b32 v194, v4 offset:640
    ds_read_b32 v195, v4 offset:896
    ds_read_b32 v196, v4 offset:2176
    ds_read_b32 v197, v4 offset:2432
    ds_read_b32 v198, v4 offset:2688
    ds_read_b32 v199, v4 offset:2944
    s_waitcnt lgkmcnt(0)
    ds_read_b32 v200, v4 offset:4224
    ds_read_b32 v201, v4 offset:4480
    ds_read_b32 v202, v4 offset:4736
    ds_read_b32 v203, v4 offset:4992
    ds_read_b32 v204, v4 offset:6272
    ds_read_b32 v205, v4 offset:6528
    ds_read_b32 v206, v4 offset:6784
    ds_read_b32 v207, v4 offset:7040
    s_waitcnt lgkmcnt(0)
    v_mfma_f32_32x32x16_bf16 v[112:127], v[176:179], a[224:227], v[112:127]
    v_mfma_f32_32x32x16_bf16 v[112:127], v[180:183], a[228:231], v[112:127]
    v_mfma_f32_32x32x16_bf16 v[112:127], v[184:187], a[232:235], v[112:127]
    v_mfma_f32_32x32x16_bf16 v[112:127], v[188:191], a[236:239], v[112:127]
    v_mfma_f32_32x32x16_bf16 v[112:127], v[192:195], a[240:243], v[112:127]
    v_mfma_f32_32x32x16_bf16 v[112:127], v[196:199], a[244:247], v[112:127]
    v_mfma_f32_32x32x16_bf16 v[112:127], v[200:203], a[248:251], v[112:127]
    v_mfma_f32_32x32x16_bf16 v[112:127], v[204:207], a[252:255], v[112:127]
    s_cmp_eq_u32 s42, 0
    s_cselect_b32 s57, -1, 0
    s_bitcmp1_b32 s40, 0
    s_cselect_b32 s64, 0, s57
    s_mov_b32 s65, 0
    s_lshl_b32 s60, s50, 15
    s_lshl_b32 s57, s42, 11
    s_add_u32 s60, s60, s57
    s_and_b32 s57, s40, 1
    s_lshl_b32 s57, s57, 14
    s_add_u32 s60, s60, s57
    s_add_u32 s60, s60, 8388608
    s_add_u32 s60, s60, s69
    s_nop 7
    s_nop 1
    v_cndmask_b32 v112, v112, v8, s[64:65]
    v_cvt_pk_bf16_f32 v16, v112, v113
    v_cvt_pk_bf16_f32 v17, v114, v115
    v_cvt_pk_bf16_f32 v18, v116, v117
    v_cvt_pk_bf16_f32 v19, v118, v119
    v_cvt_pk_bf16_f32 v20, v120, v121
    v_cvt_pk_bf16_f32 v21, v122, v123
    v_cvt_pk_bf16_f32 v22, v124, v125
    v_cvt_pk_bf16_f32 v23, v126, v127
    s_cmp_eq_u32 s46, 1
    s_cbranch_scc1 F_81
    buffer_store_dwordx4 v[16:19], v3, s[32:35], s60 offen offset:0 sc1
    buffer_store_dwordx4 v[20:23], v3, s[32:35], s60 offen offset:1024 sc1
    s_branch D_82
F_81:
    buffer_store_dwordx4 v[16:19], v3, s[32:35], s60 offen offset:0
    buffer_store_dwordx4 v[20:23], v3, s[32:35], s60 offen offset:1024
D_82:
    v_pk_add_f32 v[8:9], v[112:113], v[114:115]
    v_pk_mul_f32 v[10:11], v[112:113], v[112:113]
    v_pk_fma_f32 v[10:11], v[114:115], v[114:115], v[10:11]
    v_pk_add_f32 v[8:9], v[8:9], v[116:117]
    v_pk_fma_f32 v[10:11], v[116:117], v[116:117], v[10:11]
    v_pk_add_f32 v[8:9], v[8:9], v[118:119]
    v_pk_fma_f32 v[10:11], v[118:119], v[118:119], v[10:11]
    v_pk_add_f32 v[8:9], v[8:9], v[120:121]
    v_pk_fma_f32 v[10:11], v[120:121], v[120:121], v[10:11]
    v_pk_add_f32 v[8:9], v[8:9], v[122:123]
    v_pk_fma_f32 v[10:11], v[122:123], v[122:123], v[10:11]
    v_pk_add_f32 v[8:9], v[8:9], v[124:125]
    v_pk_fma_f32 v[10:11], v[124:125], v[124:125], v[10:11]
    v_pk_add_f32 v[8:9], v[8:9], v[126:127]
    v_pk_fma_f32 v[10:11], v[126:127], v[126:127], v[10:11]
    v_add_f32 v8, v8, v9
    v_add_f32 v9, v10, v11
    v_mov_b32 v10, v8
    v_mov_b32 v11, v9
    s_lshl_b32 s57, s50, 12
    s_lshl_b32 s58, s42, 9
    s_add_u32 s57, s57, s58
    s_and_b32 s58, s40, 1
    s_lshl_b32 s58, s58, 3
    s_add_u32 s57, s57, s58
    s_add_u32 s59, s57, 3670016
    v_permlane32_swap_b32 v8, v10
    v_permlane32_swap_b32 v9, v11
    v_lshlrev_b32 v12, 4, v1
    s_nop 0
    v_pk_add_f32 v[8:9], v[8:9], v[10:11]
    s_cmp_eq_u32 s46, 1
    s_cbranch_scc1 F_83
    buffer_store_dwordx2 v[8:9], v12, s[32:35], s59 offen sc1
    s_branch D_84
F_83:
    buffer_store_dwordx2 v[8:9], v12, s[32:35], s59 offen
D_84:
    s_waitcnt vmcnt(0)
    s_lshl_b32 s57, s43, 8
    s_lshl_b32 s58, s44, 4
    s_add_u32 s57, s57, s58
    s_lshl_b32 s58, s40, 2
    s_add_u32 s57, s57, s58
    s_add_u32 s57, s57, 208896
    v_mov_b32 v4, s57
    v_mov_b32 v5, s45
    s_cmp_eq_u32 s46, 1
    s_cbranch_scc1 F_85
    s_mov_b64 exec, 1
    buffer_store_dword v5, v4, s[32:35], 0 offen sc1
    s_mov_b64 exec, -1
    s_branch D_86
F_85:
    s_mov_b64 exec, 1
    buffer_store_dword v5, v4, s[32:35], 0 offen
    s_mov_b64 exec, -1
D_86:
    s_lshl_b32 s57, s43, 8
    s_add_u32 s57, s57, 208896
    v_lshlrev_b32 v4, 2, v0
    v_add_u32 v4, s57, v4
    s_mov_b32 s52, 400000
P_87:
    buffer_load_dword v5, v4, s[32:35], 0 offen sc1
    s_waitcnt vmcnt(0)
    v_and_b32 v6, 0xfffffff0, v5
    v_cmp_eq_u32 vcc, s45, v6
    s_cmp_eq_u64 vcc, -1
    s_cbranch_scc1 PD_88
    s_sub_u32 s52, s52, 1
    s_cmp_eq_u32 s52, 0
    s_cbranch_scc0 P_87
    v_mov_b32 v6, 6
    v_mov_b32 v7, 24
    buffer_store_dword v6, v7, s[36:39], 0 offen
PD_88:
    s_cmp_ge_u32 s44, 14
    s_cbranch_scc1 P3I_89
    s_lshl_b32 s57, s51, 12
    s_add_u32 s57, s57, 3670016
    v_lshlrev_b32 v14, 4, v1
    v_lshl_add_u32 v14, v2, 11, v14
    buffer_load_dwordx4 v[24:27], v14, s[32:35], s57 offen offset:0
    buffer_load_dwordx4 v[28:31], v14, s[32:35], s57 offen offset:512
    buffer_load_dwordx4 v[32:35], v14, s[32:35], s57 offen offset:1024
    buffer_load_dwordx4 v[36:39], v14, s[32:35], s57 offen offset:1536
    s_lshl_b32 s60, s51, 15
    s_add_u32 s60, s60, 8388608
    s_add_u32 s60, s60, s69
    buffer_load_dwordx4 v[40:43], v3, s[32:35], s60 offen offset:0 sc1
    buffer_load_dwordx4 v[44:47], v3, s[32:35], s60 offen offset:1024 sc1
    buffer_load_dwordx4 v[48:51], v3, s[32:35], s60 offen offset:2048 sc1
    buffer_load_dwordx4 v[52:55], v3, s[32:35], s60 offen offset:3072 sc1
    s_add_u32 s60, s60, 4096
    buffer_load_dwordx4 v[56:59], v3, s[32:35], s60 offen offset:0 sc1
    buffer_load_dwordx4 v[60:63], v3, s[32:35], s60 offen offset:1024 sc1
    buffer_load_dwordx4 v[64:67], v3, s[32:35], s60 offen offset:2048 sc1
    buffer_load_dwordx4 v[68:71], v3, s[32:35], s60 offen offset:3072 sc1
    s_add_u32 s60, s60, 4096
    buffer_load_dwordx4 v[72:75], v3, s[32:35], s60 offen offset:0 sc1
    buffer_load_dwordx4 v[76:79], v3, s[32:35], s60 offen offset:1024 sc1
    v_and_b32 v12, 3, v0
    v_lshlrev_b32 v12, 3, v12
    v_bfe_u32 v14, v0, 4, 1
    v_lshl_add_u32 v12, v14, 5, v12
    v_bfe_u32 v13, v0, 2, 2
    v_xor_b32 v4, 0, v13
    v_lshl_add_u32 v4, v4, 6, v12
    v_lshl_add_u32 v14, v2, 2, v13
    v_lshl_add_u32 v4, v14, 8, v4
    v_xor_b32 v5, 1, v13
    v_lshl_add_u32 v5, v5, 6, v12
    v_lshl_add_u32 v14, v2, 2, v13
    v_lshl_add_u32 v5, v14, 8, v5
    v_xor_b32 v6, 2, v13
    v_lshl_add_u32 v6, v6, 6, v12
    v_lshl_add_u32 v14, v2, 2, v13
    v_lshl_add_u32 v6, v14, 8, v6
    v_xor_b32 v7, 3, v13
    v_lshl_add_u32 v7, v7, 6, v12
    v_lshl_add_u32 v14, v2, 2, v13
    v_lshl_add_u32 v7, v14, 8, v7
    ds_read_b64_tr_b16 v[240:241], v4 offset:0
    ds_read_b64_tr_b16 v[242:243], v4 offset:2048
    ds_read_b64_tr_b16 v[244:245], v5 offset:0
    ds_read_b64_tr_b16 v[246:247], v5 offset:2048
    ds_read_b64_tr_b16 v[248:249], v4 offset:4096
    ds_read_b64_tr_b16 v[250:251], v4 offset:6144
    ds_read_b64_tr_b16 v[252:253], v5 offset:4096
    ds_read_b64_tr_b16 v[254:255], v5 offset:6144
    s_waitcnt vmcnt(9)
    s_waitcnt lgkmcnt(6)
    v_mfma_f32_32x32x16_bf16 v[112:127], v[240:243], v[40:43], 0
    s_waitcnt lgkmcnt(4)
    v_mfma_f32_32x32x16_bf16 v[128:143], v[244:247], v[40:43], 0
    s_waitcnt vmcnt(10)
    v_pk_add_f32 v[24:25], v[24:25], v[26:27]
    v_pk_add_f32 v[28:29], v[28:29], v[30:31]
    v_pk_add_f32 v[32:33], v[32:33], v[34:35]
    v_pk_add_f32 v[36:37], v[36:37], v[38:39]
    v_pk_add_f32 v[24:25], v[24:25], v[28:29]
    v_pk_add_f32 v[32:33], v[32:33], v[36:37]
    v_pk_add_f32 v[24:25], v[24:25], v[32:33]
    v_mov_b32 v26, v24
    v_mov_b32 v27, v25
    s_nop 1
    v_permlane32_swap_b32 v24, v26
    v_permlane32_swap_b32 v25, v27
    s_nop 0
    v_pk_add_f32 v[24:25], v[24:25], v[26:27]
    v_mul_f32 v8, 0x3b000000, v24
    v_mul_f32 v25, 0x3b000000, v25
    v_fma_f32 v25, -v8, v8, v25
    v_max_f32 v25, 0, v25
    v_add_f32 v25, 0x3727c5ac, v25
    v_rsq_f32 v9, v25
    s_nop 0
    v_sub_f32 v8, 0, v8
    v_cvt_pk_bf16_f32 v10, v8, v8
    v_and_b32 v11, 0xffff0000, v10
    v_sub_f32 v9, v8, v11
    v_cvt_pk_bf16_f32 v9, v9, v9
    v_and_b32 v9, 0xffff0000, v9
    v_lshrrev_b32 v11, 16, v11
    v_or_b32 v10, v11, v9
    v_cmp_gt_u32 vcc, 32, v0
    v_cndmask_b32 v26, 0, v10, vcc
    v_cndmask_b32 v27, 0, v11, vcc
    v_mov_b32 v24, 0
    v_mov_b32 v25, 0
    v_mov_b32 v28, 0
    v_mov_b32 v29, 0
    s_nop 1
    v_mfma_f32_32x32x16_bf16 v[112:127], v[104:107], v[26:29], v[112:127]
    v_mfma_f32_32x32x16_bf16 v[128:143], v[104:107], v[24:27], v[128:143]
    ds_read_b64_tr_b16 v[32:33], v4 offset:8192
    ds_read_b64_tr_b16 v[34:35], v4 offset:10240
    ds_read_b64_tr_b16 v[36:37], v5 offset:8192
    ds_read_b64_tr_b16 v[38:39], v5 offset:10240
    buffer_load_dwordx4 v[80:83], v3, s[32:35], s60 offen offset:2048 sc1
    buffer_load_dwordx4 v[84:87], v3, s[32:35], s60 offen offset:3072 sc1
    s_waitcnt vmcnt(10)
    s_waitcnt lgkmcnt(6)
    v_mfma_f32_32x32x16_bf16 v[112:127], v[248:251], v[44:47], v[112:127]
    ds_read_b64_tr_b16 v[240:241], v4 offset:12288
    ds_read_b64_tr_b16 v[242:243], v4 offset:14336
    s_waitcnt lgkmcnt(6)
    v_mfma_f32_32x32x16_bf16 v[128:143], v[252:255], v[44:47], v[128:143]
    ds_read_b64_tr_b16 v[244:245], v5 offset:12288
    ds_read_b64_tr_b16 v[246:247], v5 offset:14336
    s_add_u32 s60, s60, 4096
    buffer_load_dwordx4 v[88:91], v3, s[32:35], s60 offen offset:0 sc1
    buffer_load_dwordx4 v[92:95], v3, s[32:35], s60 offen offset:1024 sc1
    s_waitcnt vmcnt(11)
    s_waitcnt lgkmcnt(6)
    v_mfma_f32_32x32x16_bf16 v[112:127], v[32:35], v[48:51], v[112:127]
    ds_read_b64_tr_b16 v[248:249], v4 offset:16384
    ds_read_b64_tr_b16 v[250:251], v4 offset:18432
    s_waitcnt lgkmcnt(6)
    v_mfma_f32_32x32x16_bf16 v[128:143], v[36:39], v[48:51], v[128:143]
    ds_read_b64_tr_b16 v[252:253], v5 offset:16384
    ds_read_b64_tr_b16 v[254:255], v5 offset:18432
    buffer_load_dwordx4 v[96:99], v3, s[32:35], s60 offen offset:2048 sc1
    buffer_load_dwordx4 v[100:103], v3, s[32:35], s60 offen offset:3072 sc1
    s_waitcnt vmcnt(12)
    s_waitcnt lgkmcnt(6)
    v_mfma_f32_32x32x16_bf16 v[112:127], v[240:243], v[52:55], v[112:127]
    ds_read_b64_tr_b16 v[32:33], v4 offset:20480
    ds_read_b64_tr_b16 v[34:35], v4 offset:22528
    s_waitcnt lgkmcnt(6)
    v_mfma_f32_32x32x16_bf16 v[128:143], v[244:247], v[52:55], v[128:143]
    ds_read_b64_tr_b16 v[36:37], v5 offset:20480
    ds_read_b64_tr_b16 v[38:39], v5 offset:22528
    s_add_u32 s60, s60, 4096
    buffer_load_dwordx4 v[176:179], v3, s[32:35], s60 offen offset:0 sc1
    buffer_load_dwordx4 v[180:183], v3, s[32:35], s60 offen offset:1024 sc1
    s_waitcnt vmcnt(13)
    s_waitcnt lgkmcnt(6)
    v_mfma_f32_32x32x16_bf16 v[112:127], v[248:251], v[56:59], v[112:127]
    ds_read_b64_tr_b16 v[240:241], v4 offset:24576
    ds_read_b64_tr_b16 v[242:243], v4 offset:26624
    s_waitcnt lgkmcnt(6)
    v_mfma_f32_32x32x16_bf16 v[128:143], v[252:255], v[56:59], v[128:143]
    ds_read_b64_tr_b16 v[244:245], v5 offset:24576
    ds_read_b64_tr_b16 v[246:247], v5 offset:26624
    buffer_load_dwordx4 v[184:187], v3, s[32:35], s60 offen offset:2048 sc1
    buffer_load_dwordx4 v[188:191], v3, s[32:35], s60 offen offset:3072 sc1
    s_waitcnt vmcnt(14)
    s_waitcnt lgkmcnt(6)
    v_mfma_f32_32x32x16_bf16 v[112:127], v[32:35], v[60:63], v[112:127]
    ds_read_b64_tr_b16 v[248:249], v4 offset:28672
    ds_read_b64_tr_b16 v[250:251], v4 offset:30720
    s_waitcnt lgkmcnt(6)
    v_mfma_f32_32x32x16_bf16 v[128:143], v[36:39], v[60:63], v[128:143]
    ds_read_b64_tr_b16 v[252:253], v5 offset:28672
    ds_read_b64_tr_b16 v[254:255], v5 offset:30720
    s_add_u32 s60, s60, 4096
    buffer_load_dwordx4 v[192:195], v3, s[32:35], s60 offen offset:0 sc1
    buffer_load_dwordx4 v[196:199], v3, s[32:35], s60 offen offset:1024 sc1
    s_waitcnt vmcnt(15)
    s_waitcnt lgkmcnt(6)
    v_mfma_f32_32x32x16_bf16 v[112:127], v[240:243], v[64:67], v[112:127]
    ds_read_b64_tr_b16 v[32:33], v4 offset:32768
    ds_read_b64_tr_b16 v[34:35], v4 offset:34816
    s_waitcnt lgkmcnt(6)
    v_mfma_f32_32x32x16_bf16 v[128:143], v[244:247], v[64:67], v[128:143]
    ds_read_b64_tr_b16 v[36:37], v5 offset:32768
    ds_read_b64_tr_b16 v[38:39], v5 offset:34816
    buffer_load_dwordx4 v[200:203], v3, s[32:35], s60 offen offset:2048 sc1
    buffer_load_dwordx4 v[204:207], v3, s[32:35], s60 offen offset:3072 sc1
    s_waitcnt vmcnt(16)
    s_waitcnt lgkmcnt(6)
    v_mfma_f32_32x32x16_bf16 v[112:127], v[248:251], v[68:71], v[112:127]
    ds_read_b64_tr_b16 v[240:241], v4 offset:36864
    ds_read_b64_tr_b16 v[242:243], v4 offset:38912
    s_waitcnt lgkmcnt(6)
    v_mfma_f32_32x32x16_bf16 v[128:143], v[252:255], v[68:71], v[128:143]
    ds_read_b64_tr_b16 v[244:245], v5 offset:36864
    ds_read_b64_tr_b16 v[246:247], v5 offset:38912
    s_add_u32 s60, s60, 4096
    buffer_load_dwordx4 v[208:211], v3, s[32:35], s60 offen offset:0 sc1
    buffer_load_dwordx4 v[212:215], v3, s[32:35], s60 offen offset:1024 sc1
    s_waitcnt vmcnt(17)
    s_waitcnt lgkmcnt(6)
    v_mfma_f32_32x32x16_bf16 v[112:127], v[32:35], v[72:75], v[112:127]
    ds_read_b64_tr_b16 v[248:249], v4 offset:40960
    ds_read_b64_tr_b16 v[250:251], v4 offset:43008
    s_waitcnt lgkmcnt(6)
    v_mfma_f32_32x32x16_bf16 v[128:143], v[36:39], v[72:75], v[128:143]
    ds_read_b64_tr_b16 v[252:253], v5 offset:40960
    ds_read_b64_tr_b16 v[254:255], v5 offset:43008
    buffer_load_dwordx4 v[216:219], v3, s[32:35], s60 offen offset:2048 sc1
    buffer_load_dwordx4 v[220:223], v3, s[32:35], s60 offen offset:3072 sc1
    s_waitcnt vmcnt(18)
    s_waitcnt lgkmcnt(6)
    v_mfma_f32_32x32x16_bf16 v[112:127], v[240:243], v[76:79], v[112:127]
    ds_read_b64_tr_b16 v[32:33], v4 offset:45056
    ds_read_b64_tr_b16 v[34:35], v4 offset:47104
    s_waitcnt lgkmcnt(6)
    v_mfma_f32_32x32x16_bf16 v[128:143], v[244:247], v[76:79], v[128:143]
    ds_read_b64_tr_b16 v[36:37], v5 offset:45056
    ds_read_b64_tr_b16 v[38:39], v5 offset:47104
    s_add_u32 s60, s60, 4096
    buffer_load_dwordx4 v[224:227], v3, s[32:35], s60 offen offset:0 sc1
    buffer_load_dwordx4 v[228:231], v3, s[32:35], s60 offen offset:1024 sc1
    s_waitcnt vmcnt(19)
    s_waitcnt lgkmcnt(6)
    v_mfma_f32_32x32x16_bf16 v[112:127], v[248:251], v[80:83], v[112:127]
    ds_read_b64_tr_b16 v[240:241], v4 offset:49152
    ds_read_b64_tr_b16 v[242:243], v4 offset:51200
    s_waitcnt lgkmcnt(6)
    v_mfma_f32_32x32x16_bf16 v[128:143], v[252:255], v[80:83], v[128:143]
    ds_read_b64_tr_b16 v[244:245], v5 offset:49152
    ds_read_b64_tr_b16 v[246:247], v5 offset:51200
    buffer_load_dwordx4 v[232:235], v3, s[32:35], s60 offen offset:2048 sc1
    buffer_load_dwordx4 v[236:239], v3, s[32:35], s60 offen offset:3072 sc1
    s_waitcnt vmcnt(20)
    s_waitcnt lgkmcnt(6)
    v_mfma_f32_32x32x16_bf16 v[112:127], v[32:35], v[84:87], v[112:127]
    ds_read_b64_tr_b16 v[248:249], v4 offset:53248
    ds_read_b64_tr_b16 v[250:251], v4 offset:55296
    s_waitcnt lgkmcnt(6)
    v_mfma_f32_32x32x16_bf16 v[128:143], v[36:39], v[84:87], v[128:143]
    ds_read_b64_tr_b16 v[252:253], v5 offset:53248
    ds_read_b64_tr_b16 v[254:255], v5 offset:55296
    s_waitcnt vmcnt(19)
    s_waitcnt lgkmcnt(6)
    v_mfma_f32_32x32x16_bf16 v[112:127], v[240:243], v[88:91], v[112:127]
    ds_read_b64_tr_b16 v[32:33], v4 offset:57344
    ds_read_b64_tr_b16 v[34:35], v4 offset:59392
    s_waitcnt lgkmcnt(6)
    v_mfma_f32_32x32x16_bf16 v[128:143], v[244:247], v[88:91], v[128:143]
    ds_read_b64_tr_b16 v[36:37], v5 offset:57344
    ds_read_b64_tr_b16 v[38:39], v5 offset:59392
    s_waitcnt vmcnt(18)
    s_waitcnt lgkmcnt(6)
    v_mfma_f32_32x32x16_bf16 v[112:127], v[248:251], v[92:95], v[112:127]
    ds_read_b64_tr_b16 v[240:241], v4 offset:61440
    ds_read_b64_tr_b16 v[242:243], v4 offset:63488
    s_waitcnt lgkmcnt(6)
    v_mfma_f32_32x32x16_bf16 v[128:143], v[252:255], v[92:95], v[128:143]
    ds_read_b64_tr_b16 v[244:245], v5 offset:61440
    ds_read_b64_tr_b16 v[246:247], v5 offset:63488
    s_waitcnt vmcnt(17)
    s_waitcnt lgkmcnt(6)
    v_mfma_f32_32x32x16_bf16 v[112:127], v[32:35], v[96:99], v[112:127]
    v_sub_u32 v14, 4, v13
    v_and_b32 v14, 3, v14
    v_xor_b32 v14, 0, v14
    v_lshl_add_u32 v4, v14, 6, v12
    v_lshl_add_u32 v14, v2, 2, v13
    v_sub_u32 v15, 0, v14
    v_add_u32 v15, 264, v15
    v_lshl_add_u32 v4, v15, 8, v4
    v_sub_u32 v14, 4, v13
    v_and_b32 v14, 3, v14
    v_xor_b32 v14, 1, v14
    v_lshl_add_u32 v5, v14, 6, v12
    v_lshl_add_u32 v14, v2, 2, v13
    v_sub_u32 v15, 0, v14
    v_add_u32 v15, 264, v15
    v_lshl_add_u32 v5, v15, 8, v5
    v_lshl_add_u32 v14, v2, 2, v13
    v_cmp_eq_u32 vcc, 0, v14
    v_add_u32 v15, 0xffff0000, v4
    v_cndmask_b32 v15, v4, v15, vcc
    ds_read_b64_tr_b16 v[248:249], v15 offset:63488
    ds_read_b64_tr_b16 v[250:251], v4 offset:61440
    s_waitcnt lgkmcnt(6)
    v_mfma_f32_32x32x16_bf16 v[128:143], v[36:39], v[96:99], v[128:143]
    v_lshl_add_u32 v14, v2, 2, v13
    v_cmp_eq_u32 vcc, 0, v14
    v_add_u32 v15, 0xffff0000, v5
    v_cndmask_b32 v15, v5, v15, vcc
    ds_read_b64_tr_b16 v[252:253], v15 offset:63488
    ds_read_b64_tr_b16 v[254:255], v5 offset:61440
    s_waitcnt vmcnt(16)
    s_waitcnt lgkmcnt(6)
    v_mfma_f32_32x32x16_bf16 v[112:127], v[240:243], v[100:103], v[112:127]
    ds_read_b64_tr_b16 v[32:33], v4 offset:59392
    ds_read_b64_tr_b16 v[34:35], v4 offset:57344
    s_waitcnt lgkmcnt(6)
    v_mfma_f32_32x32x16_bf16 v[128:143], v[244:247], v[100:103], v[128:143]
    ds_read_b64_tr_b16 v[36:37], v5 offset:59392
    ds_read_b64_tr_b16 v[38:39], v5 offset:57344
    s_waitcnt vmcnt(15)
    s_waitcnt lgkmcnt(6)
    v_mfma_f32_32x32x16_bf16 v[112:127], v[248:251], v[176:179], v[112:127]
    ds_read_b64_tr_b16 v[240:241], v4 offset:55296
    ds_read_b64_tr_b16 v[242:243], v4 offset:53248
    s_waitcnt lgkmcnt(6)
    v_mfma_f32_32x32x16_bf16 v[128:143], v[252:255], v[176:179], v[128:143]
    ds_read_b64_tr_b16 v[244:245], v5 offset:55296
    ds_read_b64_tr_b16 v[246:247], v5 offset:53248
    s_lshl_b32 s57, s44, 2
    s_add_u32 s57, s57, 0
    s_mul_i32 s58, s57, 4682
    s_lshr_b32 s58, s58, 16
    s_mul_i32 s58, s58, 14
    s_add_u32 s57, s57, s58
    s_lshl_b32 s57, s57, 10
    s_mul_i32 s58, s51, 114688
    s_add_u32 s57, s57, s58
    s_add_u32 s53, s57, 16777216
    s_add_u32 s53, s53, s68
    s_waitcnt vmcnt(14)
    s_waitcnt lgkmcnt(6)
    v_mfma_f32_32x32x16_bf16 v[112:127], v[32:35], v[180:183], v[112:127]
    ds_read_b64_tr_b16 v[248:249], v4 offset:51200
    ds_read_b64_tr_b16 v[250:251], v4 offset:49152
    s_waitcnt lgkmcnt(6)
    v_mfma_f32_32x32x16_bf16 v[128:143], v[36:39], v[180:183], v[128:143]
    ds_read_b64_tr_b16 v[252:253], v5 offset:51200
    ds_read_b64_tr_b16 v[254:255], v5 offset:49152
    s_lshl_b32 s57, s44, 2
    s_add_u32 s57, s57, 2
    s_mul_i32 s58, s57, 4682
    s_lshr_b32 s58, s58, 16
    s_mul_i32 s58, s58, 14
    s_add_u32 s57, s57, s58
    s_lshl_b32 s57, s57, 10
    s_mul_i32 s58, s51, 114688
    s_add_u32 s57, s57, s58
    s_add_u32 s54, s57, 16777216
    s_add_u32 s54, s54, s68
    s_waitcnt vmcnt(13)
    s_waitcnt lgkmcnt(6)
    v_mfma_f32_32x32x16_bf16 v[112:127], v[240:243], v[184:187], v[112:127]
    ds_read_b64_tr_b16 v[32:33], v4 offset:47104
    ds_read_b64_tr_b16 v[34:35], v4 offset:45056
    s_waitcnt lgkmcnt(6)
    v_mfma_f32_32x32x16_bf16 v[128:143], v[244:247], v[184:187], v[128:143]
    ds_read_b64_tr_b16 v[36:37], v5 offset:47104
    ds_read_b64_tr_b16 v[38:39], v5 offset:45056
    s_lshl_b32 s57, s44, 2
    s_add_u32 s57, s57, 0
    s_mul_i32 s58, s57, 4682
    s_lshr_b32 s58, s58, 16
    s_mul_i32 s58, s58, 14
    s_add_u32 s57, s57, s58
    s_lshl_b32 s57, s57, 10
    s_mul_i32 s58, s51, 114688
    s_add_u32 s57, s57, s58
    s_add_u32 s96, s57, 16791552
    s_add_u32 s96, s96, s68
    s_waitcnt vmcnt(12)
    s_waitcnt lgkmcnt(6)
    v_mfma_f32_32x32x16_bf16 v[112:127], v[248:251], v[188:191], v[112:127]
    ds_read_b64_tr_b16 v[240:241], v4 offset:43008
    ds_read_b64_tr_b16 v[242:243], v4 offset:40960
    s_waitcnt lgkmcnt(6)
    v_mfma_f32_32x32x16_bf16 v[128:143], v[252:255], v[188:191], v[128:143]
    ds_read_b64_tr_b16 v[244:245], v5 offset:43008
    ds_read_b64_tr_b16 v[246:247], v5 offset:40960
    s_lshl_b32 s57, s44, 2
    s_add_u32 s57, s57, 2
    s_mul_i32 s58, s57, 4682
    s_lshr_b32 s58, s58, 16
    s_mul_i32 s58, s58, 14
    s_add_u32 s57, s57, s58
    s_lshl_b32 s57, s57, 10
    s_mul_i32 s58, s51, 114688
    s_add_u32 s57, s57, s58
    s_add_u32 s97, s57, 16791552
    s_add_u32 s97, s97, s68
    s_waitcnt vmcnt(11)
    s_waitcnt lgkmcnt(6)
    v_mfma_f32_32x32x16_bf16 v[112:127], v[32:35], v[192:195], v[112:127]
    ds_read_b64_tr_b16 v[248:249], v4 offset:38912
    ds_read_b64_tr_b16 v[250:251], v4 offset:36864
    s_waitcnt lgkmcnt(6)
    v_mfma_f32_32x32x16_bf16 v[128:143], v[36:39], v[192:195], v[128:143]
    ds_read_b64_tr_b16 v[252:253], v5 offset:38912
    ds_read_b64_tr_b16 v[254:255], v5 offset:36864
    s_lshr_b32 s57, s40, 1
    s_xor_b32 s57, s57, 0
    s_cmp_eq_u32 s57, 0
    s_cselect_b32 s57, s48, s49
    s_mul_i32 s57, s57, 114688
    s_mul_i32 s58, s40, 28672
    s_add_u32 s57, s57, s58
    s_add_u32 s60, s57, 16777216
    s_add_u32 s60, s60, s68
    s_lshr_b32 s57, s40, 1
    s_xor_b32 s57, s57, 1
    s_cmp_eq_u32 s57, 0
    s_cselect_b32 s57, s48, s49
    s_mul_i32 s57, s57, 114688
    s_mul_i32 s58, s40, 28672
    s_add_u32 s57, s57, s58
    s_add_u32 s61, s57, 16777216
    s_add_u32 s61, s61, s68
    s_waitcnt vmcnt(10)
    s_waitcnt lgkmcnt(6)
    v_mfma_f32_32x32x16_bf16 v[112:127], v[240:243], v[196:199], v[112:127]
    ds_read_b64_tr_b16 v[32:33], v4 offset:34816
    ds_read_b64_tr_b16 v[34:35], v4 offset:32768
    s_waitcnt lgkmcnt(6)
    v_mfma_f32_32x32x16_bf16 v[128:143], v[244:247], v[196:199], v[128:143]
    ds_read_b64_tr_b16 v[36:37], v5 offset:34816
    ds_read_b64_tr_b16 v[38:39], v5 offset:32768
    s_waitcnt vmcnt(9)
    s_waitcnt lgkmcnt(6)
    v_mfma_f32_32x32x16_bf16 v[112:127], v[248:251], v[200:203], v[112:127]
    ds_read_b64_tr_b16 v[240:241], v4 offset:30720
    ds_read_b64_tr_b16 v[242:243], v4 offset:28672
    s_waitcnt lgkmcnt(6)
    v_mfma_f32_32x32x16_bf16 v[128:143], v[252:255], v[200:203], v[128:143]
    ds_read_b64_tr_b16 v[244:245], v5 offset:30720
    ds_read_b64_tr_b16 v[246:247], v5 offset:28672
    s_lshl_b32 s57, s43, 8
    s_lshl_b32 s58, s44, 4
    s_add_u32 s57, s57, s58
    s_lshl_b32 s58, s40, 2
    s_add_u32 s57, s57, s58
    s_add_u32 s57, s57, 217088
    v_mov_b32 v8, s57
    v_mov_b32 v9, s45
    s_waitcnt vmcnt(8)
    s_waitcnt lgkmcnt(6)
    v_mfma_f32_32x32x16_bf16 v[112:127], v[32:35], v[204:207], v[112:127]
    ds_read_b64_tr_b16 v[248:249], v4 offset:26624
    ds_read_b64_tr_b16 v[250:251], v4 offset:24576
    s_waitcnt lgkmcnt(6)
    v_mfma_f32_32x32x16_bf16 v[128:143], v[36:39], v[204:207], v[128:143]
    ds_read_b64_tr_b16 v[252:253], v5 offset:26624
    ds_read_b64_tr_b16 v[254:255], v5 offset:24576
    s_lshl_b32 s57, s43, 8
    s_add_u32 s57, s57, 217088
    v_lshlrev_b32 v10, 2, v0
    v_add_u32 v10, s57, v10
    s_waitcnt vmcnt(7)
    s_waitcnt lgkmcnt(6)
    v_mfma_f32_32x32x16_bf16 v[112:127], v[240:243], v[208:211], v[112:127]
    ds_read_b64_tr_b16 v[32:33], v4 offset:22528
    ds_read_b64_tr_b16 v[34:35], v4 offset:20480
    s_waitcnt lgkmcnt(6)
    v_mfma_f32_32x32x16_bf16 v[128:143], v[244:247], v[208:211], v[128:143]
    ds_read_b64_tr_b16 v[36:37], v5 offset:22528
    ds_read_b64_tr_b16 v[38:39], v5 offset:20480
    s_waitcnt vmcnt(6)
    s_waitcnt lgkmcnt(6)
    v_mfma_f32_32x32x16_bf16 v[112:127], v[248:251], v[212:215], v[112:127]
    ds_read_b64_tr_b16 v[240:241], v4 offset:18432
    ds_read_b64_tr_b16 v[242:243], v4 offset:16384
    s_waitcnt lgkmcnt(6)
    v_mfma_f32_32x32x16_bf16 v[128:143], v[252:255], v[212:215], v[128:143]
    ds_read_b64_tr_b16 v[244:245], v5 offset:18432
    ds_read_b64_tr_b16 v[246:247], v5 offset:16384
    s_waitcnt vmcnt(5)
    s_waitcnt lgkmcnt(6)
    v_mfma_f32_32x32x16_bf16 v[112:127], v[32:35], v[216:219], v[112:127]
    ds_read_b64_tr_b16 v[248:249], v4 offset:14336
    ds_read_b64_tr_b16 v[250:251], v4 offset:12288
    s_waitcnt lgkmcnt(6)
    v_mfma_f32_32x32x16_bf16 v[128:143], v[36:39], v[216:219], v[128:143]
    ds_read_b64_tr_b16 v[252:253], v5 offset:14336
    ds_read_b64_tr_b16 v[254:255], v5 offset:12288
    s_waitcnt vmcnt(4)
    s_waitcnt lgkmcnt(6)
    v_mfma_f32_32x32x16_bf16 v[112:127], v[240:243], v[220:223], v[112:127]
    ds_read_b64_tr_b16 v[32:33], v4 offset:10240
    ds_read_b64_tr_b16 v[34:35], v4 offset:8192
    s_waitcnt lgkmcnt(6)
    v_mfma_f32_32x32x16_bf16 v[128:143], v[244:247], v[220:223], v[128:143]
    ds_read_b64_tr_b16 v[36:37], v5 offset:10240
    ds_read_b64_tr_b16 v[38:39], v5 offset:8192
    s_waitcnt vmcnt(3)
    s_waitcnt lgkmcnt(6)
    v_mfma_f32_32x32x16_bf16 v[112:127], v[248:251], v[224:227], v[112:127]
    ds_read_b64_tr_b16 v[240:241], v4 offset:6144
    ds_read_b64_tr_b16 v[242:243], v4 offset:4096
    s_waitcnt lgkmcnt(6)
    v_mfma_f32_32x32x16_bf16 v[128:143], v[252:255], v[224:227], v[128:143]
    ds_read_b64_tr_b16 v[244:245], v5 offset:6144
    ds_read_b64_tr_b16 v[246:247], v5 offset:4096
    s_waitcnt vmcnt(2)
    s_waitcnt lgkmcnt(6)
    v_mfma_f32_32x32x16_bf16 v[112:127], v[32:35], v[228:231], v[112:127]
    ds_read_b64_tr_b16 v[248:249], v4 offset:2048
    ds_read_b64_tr_b16 v[250:251], v4 offset:0
    s_waitcnt lgkmcnt(6)
    v_mfma_f32_32x32x16_bf16 v[128:143], v[36:39], v[228:231], v[128:143]
    ds_read_b64_tr_b16 v[252:253], v5 offset:2048
    ds_read_b64_tr_b16 v[254:255], v5 offset:0
    s_waitcnt vmcnt(1)
    s_waitcnt lgkmcnt(6)
    v_mfma_f32_32x32x16_bf16 v[112:127], v[240:243], v[232:235], v[112:127]
    ds_read_b64_tr_b16 v[32:33], v6 offset:0
    ds_read_b64_tr_b16 v[34:35], v6 offset:2048
    s_waitcnt lgkmcnt(6)
    v_mfma_f32_32x32x16_bf16 v[128:143], v[244:247], v[232:235], v[128:143]
    ds_read_b64_tr_b16 v[36:37], v7 offset:0
    ds_read_b64_tr_b16 v[38:39], v7 offset:2048
    s_waitcnt vmcnt(0)
    s_waitcnt lgkmcnt(6)
    v_mfma_f32_32x32x16_bf16 v[112:127], v[248:251], v[236:239], v[112:127]
    ds_read_b64_tr_b16 v[240:241], v6 offset:4096
    ds_read_b64_tr_b16 v[242:243], v6 offset:6144
    s_waitcnt lgkmcnt(6)
    v_mfma_f32_32x32x16_bf16 v[128:143], v[252:255], v[236:239], v[128:143]
    ds_read_b64_tr_b16 v[244:245], v7 offset:4096
    ds_read_b64_tr_b16 v[246:247], v7 offset:6144
    s_waitcnt lgkmcnt(6)
    v_mfma_f32_32x32x16_bf16 v[144:159], v[32:35], v[40:43], 0
    ds_read_b64_tr_b16 v[248:249], v6 offset:8192
    ds_read_b64_tr_b16 v[250:251], v6 offset:10240
    s_waitcnt lgkmcnt(6)
    v_mfma_f32_32x32x16_bf16 v[160:175], v[36:39], v[40:43], 0
    ds_read_b64_tr_b16 v[252:253], v7 offset:8192
    ds_read_b64_tr_b16 v[254:255], v7 offset:10240
    v_mfma_f32_32x32x16_bf16 v[144:159], v[108:111], v[26:29], v[144:159]
    v_mfma_f32_32x32x16_bf16 v[160:175], v[108:111], v[24:27], v[160:175]
    s_waitcnt lgkmcnt(6)
    v_mfma_f32_32x32x16_bf16 v[144:159], v[240:243], v[44:47], v[144:159]
    ds_read_b64_tr_b16 v[32:33], v6 offset:12288
    ds_read_b64_tr_b16 v[34:35], v6 offset:14336
    s_waitcnt lgkmcnt(6)
    v_mfma_f32_32x32x16_bf16 v[160:175], v[244:247], v[44:47], v[160:175]
    ds_read_b64_tr_b16 v[36:37], v7 offset:12288
    ds_read_b64_tr_b16 v[38:39], v7 offset:14336
    s_waitcnt lgkmcnt(6)
    v_mfma_f32_32x32x16_bf16 v[144:159], v[248:251], v[48:51], v[144:159]
    ds_read_b64_tr_b16 v[240:241], v6 offset:16384
    ds_read_b64_tr_b16 v[242:243], v6 offset:18432
    s_waitcnt lgkmcnt(6)
    v_mfma_f32_32x32x16_bf16 v[160:175], v[252:255], v[48:51], v[160:175]
    ds_read_b64_tr_b16 v[244:245], v7 offset:16384
    ds_read_b64_tr_b16 v[246:247], v7 offset:18432
    v_cvt_pk_bf16_f32 v112, v112, v113
    v_cvt_pk_bf16_f32 v113, v114, v115
    v_cvt_pk_bf16_f32 v114, v116, v117
    v_cvt_pk_bf16_f32 v115, v118, v119
    v_cvt_pk_bf16_f32 v116, v120, v121
    v_cvt_pk_bf16_f32 v117, v122, v123
    v_cvt_pk_bf16_f32 v118, v124, v125
    v_cvt_pk_bf16_f32 v119, v126, v127
    s_waitcnt lgkmcnt(6)
    v_mfma_f32_32x32x16_bf16 v[144:159], v[32:35], v[52:55], v[144:159]
    ds_read_b64_tr_b16 v[248:249], v6 offset:20480
    ds_read_b64_tr_b16 v[250:251], v6 offset:22528
    s_waitcnt lgkmcnt(6)
    v_mfma_f32_32x32x16_bf16 v[160:175], v[36:39], v[52:55], v[160:175]
    ds_read_b64_tr_b16 v[252:253], v7 offset:20480
    ds_read_b64_tr_b16 v[254:255], v7 offset:22528
    v_pk_max_i16 v112, v112, 0
    v_pk_max_i16 v113, v113, 0
    v_pk_max_i16 v114, v114, 0
    v_pk_max_i16 v115, v115, 0
    v_pk_max_i16 v116, v116, 0
    v_pk_max_i16 v117, v117, 0
    v_pk_max_i16 v118, v118, 0
    v_pk_max_i16 v119, v119, 0
    s_cmp_eq_u32 s46, 1
    s_cbranch_scc1 F_91
    buffer_store_dwordx4 v[112:115], v3, s[32:35], s53 offen offset:0 sc1
    buffer_store_dwordx4 v[116:119], v3, s[32:35], s53 offen offset:1024 sc1
    s_branch D_92
F_91:
    buffer_store_dwordx4 v[112:115], v3, s[32:35], s53 offen offset:0
    buffer_store_dwordx4 v[116:119], v3, s[32:35], s53 offen offset:1024
D_92:
    s_waitcnt lgkmcnt(6)
    v_mfma_f32_32x32x16_bf16 v[144:159], v[240:243], v[56:59], v[144:159]
    ds_read_b64_tr_b16 v[32:33], v6 offset:24576
    ds_read_b64_tr_b16 v[34:35], v6 offset:26624
    s_waitcnt lgkmcnt(6)
    v_mfma_f32_32x32x16_bf16 v[160:175], v[244:247], v[56:59], v[160:175]
    ds_read_b64_tr_b16 v[36:37], v7 offset:24576
    ds_read_b64_tr_b16 v[38:39], v7 offset:26624
    v_cvt_pk_bf16_f32 v128, v128, v129
    v_cvt_pk_bf16_f32 v129, v130, v131
    v_cvt_pk_bf16_f32 v130, v132, v133
    v_cvt_pk_bf16_f32 v131, v134, v135
    v_cvt_pk_bf16_f32 v132, v136, v137
    v_cvt_pk_bf16_f32 v133, v138, v139
    v_cvt_pk_bf16_f32 v134, v140, v141
    v_cvt_pk_bf16_f32 v135, v142, v143
    s_waitcnt lgkmcnt(6)
    v_mfma_f32_32x32x16_bf16 v[144:159], v[248:251], v[60:63], v[144:159]
    ds_read_b64_tr_b16 v[240:241], v6 offset:28672
    ds_read_b64_tr_b16 v[242:243], v6 offset:30720
    s_waitcnt lgkmcnt(6)
    v_mfma_f32_32x32x16_bf16 v[160:175], v[252:255], v[60:63], v[160:175]
    ds_read_b64_tr_b16 v[244:245], v7 offset:28672
    ds_read_b64_tr_b16 v[246:247], v7 offset:30720
    v_pk_max_i16 v128, v128, 0
    v_pk_max_i16 v129, v129, 0
    v_pk_max_i16 v130, v130, 0
    v_pk_max_i16 v131, v131, 0
    v_pk_max_i16 v132, v132, 0
    v_pk_max_i16 v133, v133, 0
    v_pk_max_i16 v134, v134, 0
    v_pk_max_i16 v135, v135, 0
    s_cmp_eq_u32 s46, 1
    s_cbranch_scc1 F_93
    buffer_store_dwordx4 v[128:131], v3, s[32:35], s54 offen offset:0 sc1
    buffer_store_dwordx4 v[132:135], v3, s[32:35], s54 offen offset:1024 sc1
    s_branch D_94
F_93:
    buffer_store_dwordx4 v[128:131], v3, s[32:35], s54 offen offset:0
    buffer_store_dwordx4 v[132:135], v3, s[32:35], s54 offen offset:1024
D_94:
    s_waitcnt lgkmcnt(6)
    v_mfma_f32_32x32x16_bf16 v[144:159], v[32:35], v[64:67], v[144:159]
    ds_read_b64_tr_b16 v[248:249], v6 offset:32768
    ds_read_b64_tr_b16 v[250:251], v6 offset:34816
    s_waitcnt lgkmcnt(6)
    v_mfma_f32_32x32x16_bf16 v[160:175], v[36:39], v[64:67], v[160:175]
    ds_read_b64_tr_b16 v[252:253], v7 offset:32768
    ds_read_b64_tr_b16 v[254:255], v7 offset:34816
    s_waitcnt lgkmcnt(6)
    v_mfma_f32_32x32x16_bf16 v[144:159], v[240:243], v[68:71], v[144:159]
    ds_read_b64_tr_b16 v[32:33], v6 offset:36864
    ds_read_b64_tr_b16 v[34:35], v6 offset:38912
    s_waitcnt lgkmcnt(6)
    v_mfma_f32_32x32x16_bf16 v[160:175], v[244:247], v[68:71], v[160:175]
    ds_read_b64_tr_b16 v[36:37], v7 offset:36864
    ds_read_b64_tr_b16 v[38:39], v7 offset:38912
    s_waitcnt lgkmcnt(6)
    v_mfma_f32_32x32x16_bf16 v[144:159], v[248:251], v[72:75], v[144:159]
    ds_read_b64_tr_b16 v[240:241], v6 offset:40960
    ds_read_b64_tr_b16 v[242:243], v6 offset:43008
    s_waitcnt lgkmcnt(6)
    v_mfma_f32_32x32x16_bf16 v[160:175], v[252:255], v[72:75], v[160:175]
    ds_read_b64_tr_b16 v[244:245], v7 offset:40960
    ds_read_b64_tr_b16 v[246:247], v7 offset:43008
    s_waitcnt lgkmcnt(6)
    v_mfma_f32_32x32x16_bf16 v[144:159], v[32:35], v[76:79], v[144:159]
    ds_read_b64_tr_b16 v[248:249], v6 offset:45056
    ds_read_b64_tr_b16 v[250:251], v6 offset:47104
    s_waitcnt lgkmcnt(6)
    v_mfma_f32_32x32x16_bf16 v[160:175], v[36:39], v[76:79], v[160:175]
    ds_read_b64_tr_b16 v[252:253], v7 offset:45056
    ds_read_b64_tr_b16 v[254:255], v7 offset:47104
    s_waitcnt lgkmcnt(6)
    v_mfma_f32_32x32x16_bf16 v[144:159], v[240:243], v[80:83], v[144:159]
    ds_read_b64_tr_b16 v[32:33], v6 offset:49152
    ds_read_b64_tr_b16 v[34:35], v6 offset:51200
    s_waitcnt lgkmcnt(6)
    v_mfma_f32_32x32x16_bf16 v[160:175], v[244:247], v[80:83], v[160:175]
    ds_read_b64_tr_b16 v[36:37], v7 offset:49152
    ds_read_b64_tr_b16 v[38:39], v7 offset:51200
    s_waitcnt lgkmcnt(6)
    v_mfma_f32_32x32x16_bf16 v[144:159], v[248:251], v[84:87], v[144:159]
    ds_read_b64_tr_b16 v[240:241], v6 offset:53248
    ds_read_b64_tr_b16 v[242:243], v6 offset:55296
    s_waitcnt lgkmcnt(6)
    v_mfma_f32_32x32x16_bf16 v[160:175], v[252:255], v[84:87], v[160:175]
    ds_read_b64_tr_b16 v[244:245], v7 offset:53248
    ds_read_b64_tr_b16 v[246:247], v7 offset:55296
    s_waitcnt lgkmcnt(6)
    v_mfma_f32_32x32x16_bf16 v[144:159], v[32:35], v[88:91], v[144:159]
    ds_read_b64_tr_b16 v[248:249], v6 offset:57344
    ds_read_b64_tr_b16 v[250:251], v6 offset:59392
    s_waitcnt lgkmcnt(6)
    v_mfma_f32_32x32x16_bf16 v[160:175], v[36:39], v[88:91], v[160:175]
    ds_read_b64_tr_b16 v[252:253], v7 offset:57344
    ds_read_b64_tr_b16 v[254:255], v7 offset:59392
    s_waitcnt vmcnt(0)
    s_cmp_eq_u32 s46, 1
    s_cbranch_scc1 F_95
    s_mov_b64 exec, 1
    buffer_store_dword v9, v8, s[32:35], 0 offen sc1
    s_mov_b64 exec, -1
    s_branch D_96
F_95:
    s_mov_b64 exec, 1
    buffer_store_dword v9, v8, s[32:35], 0 offen
    s_mov_b64 exec, -1
D_96:
    s_waitcnt lgkmcnt(6)
    v_mfma_f32_32x32x16_bf16 v[144:159], v[240:243], v[92:95], v[144:159]
    ds_read_b64_tr_b16 v[32:33], v6 offset:61440
    ds_read_b64_tr_b16 v[34:35], v6 offset:63488
    s_waitcnt lgkmcnt(6)
    v_mfma_f32_32x32x16_bf16 v[160:175], v[244:247], v[92:95], v[160:175]
    ds_read_b64_tr_b16 v[36:37], v7 offset:61440
    ds_read_b64_tr_b16 v[38:39], v7 offset:63488
    s_waitcnt lgkmcnt(6)
    v_mfma_f32_32x32x16_bf16 v[144:159], v[248:251], v[96:99], v[144:159]
    v_sub_u32 v14, 4, v13
    v_and_b32 v14, 3, v14
    v_xor_b32 v14, 2, v14
    v_lshl_add_u32 v6, v14, 6, v12
    v_lshl_add_u32 v14, v2, 2, v13
    v_sub_u32 v15, 0, v14
    v_add_u32 v15, 264, v15
    v_lshl_add_u32 v6, v15, 8, v6
    v_sub_u32 v14, 4, v13
    v_and_b32 v14, 3, v14
    v_xor_b32 v14, 3, v14
    v_lshl_add_u32 v7, v14, 6, v12
    v_lshl_add_u32 v14, v2, 2, v13
    v_sub_u32 v15, 0, v14
    v_add_u32 v15, 264, v15
    v_lshl_add_u32 v7, v15, 8, v7
    v_lshl_add_u32 v14, v2, 2, v13
    v_cmp_eq_u32 vcc, 0, v14
    v_add_u32 v15, 0xffff0000, v6
    v_cndmask_b32 v15, v6, v15, vcc
    ds_read_b64_tr_b16 v[240:241], v15 offset:63488
    ds_read_b64_tr_b16 v[242:243], v6 offset:61440
    s_waitcnt lgkmcnt(6)
    v_mfma_f32_32x32x16_bf16 v[160:175], v[252:255], v[96:99], v[160:175]
    v_lshl_add_u32 v14, v2, 2, v13
    v_cmp_eq_u32 vcc, 0, v14
    v_add_u32 v15, 0xffff0000, v7
    v_cndmask_b32 v15, v7, v15, vcc
    ds_read_b64_tr_b16 v[244:245], v15 offset:63488
    ds_read_b64_tr_b16 v[246:247], v7 offset:61440
    s_waitcnt lgkmcnt(6)
    v_mfma_f32_32x32x16_bf16 v[144:159], v[32:35], v[100:103], v[144:159]
    ds_read_b64_tr_b16 v[248:249], v6 offset:59392
    ds_read_b64_tr_b16 v[250:251], v6 offset:57344
    s_waitcnt lgkmcnt(6)
    v_mfma_f32_32x32x16_bf16 v[160:175], v[36:39], v[100:103], v[160:175]
    ds_read_b64_tr_b16 v[252:253], v7 offset:59392
    ds_read_b64_tr_b16 v[254:255], v7 offset:57344
    s_waitcnt lgkmcnt(6)
    v_mfma_f32_32x32x16_bf16 v[144:159], v[240:243], v[176:179], v[144:159]
    ds_read_b64_tr_b16 v[32:33], v6 offset:55296
    ds_read_b64_tr_b16 v[34:35], v6 offset:53248
    s_waitcnt lgkmcnt(6)
    v_mfma_f32_32x32x16_bf16 v[160:175], v[244:247], v[176:179], v[160:175]
    ds_read_b64_tr_b16 v[36:37], v7 offset:55296
    ds_read_b64_tr_b16 v[38:39], v7 offset:53248
    s_waitcnt lgkmcnt(6)
    v_mfma_f32_32x32x16_bf16 v[144:159], v[248:251], v[180:183], v[144:159]
    ds_read_b64_tr_b16 v[240:241], v6 offset:51200
    ds_read_b64_tr_b16 v[242:243], v6 offset:49152
    s_waitcnt lgkmcnt(6)
    v_mfma_f32_32x32x16_bf16 v[160:175], v[252:255], v[180:183], v[160:175]
    ds_read_b64_tr_b16 v[244:245], v7 offset:51200
    ds_read_b64_tr_b16 v[246:247], v7 offset:49152
    s_waitcnt lgkmcnt(6)
    v_mfma_f32_32x32x16_bf16 v[144:159], v[32:35], v[184:187], v[144:159]
    ds_read_b64_tr_b16 v[248:249], v6 offset:47104
    ds_read_b64_tr_b16 v[250:251], v6 offset:45056
    s_waitcnt lgkmcnt(6)
    v_mfma_f32_32x32x16_bf16 v[160:175], v[36:39], v[184:187], v[160:175]
    ds_read_b64_tr_b16 v[252:253], v7 offset:47104
    ds_read_b64_tr_b16 v[254:255], v7 offset:45056
    s_waitcnt lgkmcnt(6)
    v_mfma_f32_32x32x16_bf16 v[144:159], v[240:243], v[188:191], v[144:159]
    ds_read_b64_tr_b16 v[32:33], v6 offset:43008
    ds_read_b64_tr_b16 v[34:35], v6 offset:40960
    s_waitcnt lgkmcnt(6)
    v_mfma_f32_32x32x16_bf16 v[160:175], v[244:247], v[188:191], v[160:175]
    ds_read_b64_tr_b16 v[36:37], v7 offset:43008
    ds_read_b64_tr_b16 v[38:39], v7 offset:40960
    s_waitcnt lgkmcnt(6)
    v_mfma_f32_32x32x16_bf16 v[144:159], v[248:251], v[192:195], v[144:159]
    ds_read_b64_tr_b16 v[240:241], v6 offset:38912
    ds_read_b64_tr_b16 v[242:243], v6 offset:36864
    s_waitcnt lgkmcnt(6)
    v_mfma_f32_32x32x16_bf16 v[160:175], v[252:255], v[192:195], v[160:175]
    ds_read_b64_tr_b16 v[244:245], v7 offset:38912
    ds_read_b64_tr_b16 v[246:247], v7 offset:36864
    buffer_load_dword v11, v10, s[32:35], 0 offen sc1
    s_waitcnt lgkmcnt(6)
    v_mfma_f32_32x32x16_bf16 v[144:159], v[32:35], v[196:199], v[144:159]
    ds_read_b64_tr_b16 v[248:249], v6 offset:34816
    ds_read_b64_tr_b16 v[250:251], v6 offset:32768
    s_waitcnt lgkmcnt(6)
    v_mfma_f32_32x32x16_bf16 v[160:175], v[36:39], v[196:199], v[160:175]
    ds_read_b64_tr_b16 v[252:253], v7 offset:34816
    ds_read_b64_tr_b16 v[254:255], v7 offset:32768
    s_waitcnt lgkmcnt(6)
    v_mfma_f32_32x32x16_bf16 v[144:159], v[240:243], v[200:203], v[144:159]
    ds_read_b64_tr_b16 v[32:33], v6 offset:30720
    ds_read_b64_tr_b16 v[34:35], v6 offset:28672
    s_waitcnt lgkmcnt(6)
    v_mfma_f32_32x32x16_bf16 v[160:175], v[244:247], v[200:203], v[160:175]
    ds_read_b64_tr_b16 v[36:37], v7 offset:30720
    ds_read_b64_tr_b16 v[38:39], v7 offset:28672
    s_waitcnt lgkmcnt(6)
    v_mfma_f32_32x32x16_bf16 v[144:159], v[248:251], v[204:207], v[144:159]
    ds_read_b64_tr_b16 v[240:241], v6 offset:26624
    ds_read_b64_tr_b16 v[242:243], v6 offset:24576
    s_waitcnt lgkmcnt(6)
    v_mfma_f32_32x32x16_bf16 v[160:175], v[252:255], v[204:207], v[160:175]
    ds_read_b64_tr_b16 v[244:245], v7 offset:26624
    ds_read_b64_tr_b16 v[246:247], v7 offset:24576
    s_waitcnt lgkmcnt(6)
    v_mfma_f32_32x32x16_bf16 v[144:159], v[32:35], v[208:211], v[144:159]
    ds_read_b64_tr_b16 v[248:249], v6 offset:22528
    ds_read_b64_tr_b16 v[250:251], v6 offset:20480
    s_waitcnt lgkmcnt(6)
    v_mfma_f32_32x32x16_bf16 v[160:175], v[36:39], v[208:211], v[160:175]
    ds_read_b64_tr_b16 v[252:253], v7 offset:22528
    ds_read_b64_tr_b16 v[254:255], v7 offset:20480
    s_waitcnt lgkmcnt(6)
    v_mfma_f32_32x32x16_bf16 v[144:159], v[240:243], v[212:215], v[144:159]
    ds_read_b64_tr_b16 v[32:33], v6 offset:18432
    ds_read_b64_tr_b16 v[34:35], v6 offset:16384
    s_waitcnt lgkmcnt(6)
    v_mfma_f32_32x32x16_bf16 v[160:175], v[244:247], v[212:215], v[160:175]
    ds_read_b64_tr_b16 v[36:37], v7 offset:18432
    ds_read_b64_tr_b16 v[38:39], v7 offset:16384
    s_waitcnt vmcnt(0)
    v_and_b32 v12, 0xfffffff0, v11
    v_cmp_eq_u32 vcc, s45, v12
    s_cmp_eq_u64 vcc, -1
    s_cbranch_scc1 FC_97
    s_mov_b32 s52, 400000
P_98:
    buffer_load_dword v11, v10, s[32:35], 0 offen sc1
    s_waitcnt vmcnt(0)
    v_and_b32 v12, 0xfffffff0, v11
    v_cmp_eq_u32 vcc, s45, v12
    s_cmp_eq_u64 vcc, -1
    s_cbranch_scc1 PD_99
    s_sub_u32 s52, s52, 1
    s_cmp_eq_u32 s52, 0
    s_cbranch_scc0 P_98
    v_mov_b32 v12, 8
    v_mov_b32 v13, 32
    buffer_store_dword v12, v13, s[36:39], 0 offen
PD_99:
FC_97:
    s_waitcnt lgkmcnt(6)
    v_mfma_f32_32x32x16_bf16 v[144:159], v[248:251], v[216:219], v[144:159]
    ds_read_b64_tr_b16 v[240:241], v6 offset:14336
    ds_read_b64_tr_b16 v[242:243], v6 offset:12288
    s_waitcnt lgkmcnt(6)
    v_mfma_f32_32x32x16_bf16 v[160:175], v[252:255], v[216:219], v[160:175]
    ds_read_b64_tr_b16 v[244:245], v7 offset:14336
    ds_read_b64_tr_b16 v[246:247], v7 offset:12288
    buffer_load_dwordx4 v[176:179], v3, s[32:35], s61 offen offset:0 sc1
    buffer_load_dwordx4 v[180:183], v3, s[32:35], s61 offen offset:1024 sc1
    s_waitcnt lgkmcnt(6)
    v_mfma_f32_32x32x16_bf16 v[144:159], v[32:35], v[220:223], v[144:159]
    ds_read_b64_tr_b16 v[248:249], v6 offset:10240
    ds_read_b64_tr_b16 v[250:251], v6 offset:8192
    s_waitcnt lgkmcnt(6)
    v_mfma_f32_32x32x16_bf16 v[160:175], v[36:39], v[220:223], v[160:175]
    ds_read_b64_tr_b16 v[252:253], v7 offset:10240
    ds_read_b64_tr_b16 v[254:255], v7 offset:8192
    buffer_load_dwordx4 v[184:187], v3, s[32:35], s61 offen offset:2048 sc1
    buffer_load_dwordx4 v[188:191], v3, s[32:35], s61 offen offset:3072 sc1
    s_waitcnt lgkmcnt(6)
    v_mfma_f32_32x32x16_bf16 v[144:159], v[240:243], v[224:227], v[144:159]
    ds_read_b64_tr_b16 v[32:33], v6 offset:6144
    ds_read_b64_tr_b16 v[34:35], v6 offset:4096
    s_waitcnt lgkmcnt(6)
    v_mfma_f32_32x32x16_bf16 v[160:175], v[244:247], v[224:227], v[160:175]
    ds_read_b64_tr_b16 v[36:37], v7 offset:6144
    ds_read_b64_tr_b16 v[38:39], v7 offset:4096
    s_add_u32 s61, s61, 4096
    buffer_load_dwordx4 v[192:195], v3, s[32:35], s61 offen offset:0 sc1
    buffer_load_dwordx4 v[196:199], v3, s[32:35], s61 offen offset:1024 sc1
    s_waitcnt lgkmcnt(6)
    v_mfma_f32_32x32x16_bf16 v[144:159], v[248:251], v[228:231], v[144:159]
    ds_read_b64_tr_b16 v[240:241], v6 offset:2048
    ds_read_b64_tr_b16 v[242:243], v6 offset:0
    s_waitcnt lgkmcnt(6)
    v_mfma_f32_32x32x16_bf16 v[160:175], v[252:255], v[228:231], v[160:175]
    ds_read_b64_tr_b16 v[244:245], v7 offset:2048
    ds_read_b64_tr_b16 v[246:247], v7 offset:0
    buffer_load_dwordx4 v[200:203], v3, s[32:35], s61 offen offset:2048 sc1
    buffer_load_dwordx4 v[204:207], v3, s[32:35], s61 offen offset:3072 sc1
    s_waitcnt lgkmcnt(6)
    v_mfma_f32_32x32x16_bf16 v[144:159], v[32:35], v[232:235], v[144:159]
    s_waitcnt lgkmcnt(4)
    v_mfma_f32_32x32x16_bf16 v[160:175], v[36:39], v[232:235], v[160:175]
    s_waitcnt lgkmcnt(2)
    v_mfma_f32_32x32x16_bf16 v[144:159], v[240:243], v[236:239], v[144:159]
    s_waitcnt lgkmcnt(0)
    v_mfma_f32_32x32x16_bf16 v[160:175], v[244:247], v[236:239], v[160:175]
    s_lshl_b32 s57, s50, 12
    s_add_u32 s57, s57, 3670016
    v_lshlrev_b32 v14, 4, v1
    v_lshl_add_u32 v14, v2, 11, v14
    buffer_load_dwordx4 v[208:211], v14, s[32:35], s57 offen offset:0
    buffer_load_dwordx4 v[212:215], v14, s[32:35], s57 offen offset:512
    buffer_load_dwordx4 v[216:219], v14, s[32:35], s57 offen offset:1024
    buffer_load_dwordx4 v[220:223], v14, s[32:35], s57 offen offset:1536
    s_nop 1
    v_cvt_pk_bf16_f32 v144, v144, v145
    v_cvt_pk_bf16_f32 v145, v146, v147
    v_cvt_pk_bf16_f32 v146, v148, v149
    v_cvt_pk_bf16_f32 v147, v150, v151
    v_cvt_pk_bf16_f32 v148, v152, v153
    v_cvt_pk_bf16_f32 v149, v154, v155
    v_cvt_pk_bf16_f32 v150, v156, v157
    v_cvt_pk_bf16_f32 v151, v158, v159
    v_pk_max_i16 v144, v144, 0
    v_pk_max_i16 v145, v145, 0
    v_pk_max_i16 v146, v146, 0
    v_pk_max_i16 v147, v147, 0
    v_pk_max_i16 v148, v148, 0
    v_pk_max_i16 v149, v149, 0
    v_pk_max_i16 v150, v150, 0
    v_pk_max_i16 v151, v151, 0
    s_cmp_eq_u32 s46, 1
    s_cbranch_scc1 F_100
    buffer_store_dwordx4 v[144:147], v3, s[32:35], s96 offen offset:0 sc1
    buffer_store_dwordx4 v[148:151], v3, s[32:35], s96 offen offset:1024 sc1
    s_branch D_101
F_100:
    buffer_store_dwordx4 v[144:147], v3, s[32:35], s96 offen offset:0
    buffer_store_dwordx4 v[148:151], v3, s[32:35], s96 offen offset:1024
D_101:
    v_cvt_pk_bf16_f32 v160, v160, v161
    v_cvt_pk_bf16_f32 v161, v162, v163
    v_cvt_pk_bf16_f32 v162, v164, v165
    v_cvt_pk_bf16_f32 v163, v166, v167
    v_cvt_pk_bf16_f32 v164, v168, v169
    v_cvt_pk_bf16_f32 v165, v170, v171
    v_cvt_pk_bf16_f32 v166, v172, v173
    v_cvt_pk_bf16_f32 v167, v174, v175
    v_pk_max_i16 v160, v160, 0
    v_pk_max_i16 v161, v161, 0
    v_pk_max_i16 v162, v162, 0
    v_pk_max_i16 v163, v163, 0
    v_pk_max_i16 v164, v164, 0
    v_pk_max_i16 v165, v165, 0
    v_pk_max_i16 v166, v166, 0
    v_pk_max_i16 v167, v167, 0
    s_cmp_eq_u32 s46, 1
    s_cbranch_scc1 F_102
    buffer_store_dwordx4 v[160:163], v3, s[32:35], s97 offen offset:0 sc1
    buffer_store_dwordx4 v[164:167], v3, s[32:35], s97 offen offset:1024 sc1
    s_branch D_103
F_102:
    buffer_store_dwordx4 v[160:163], v3, s[32:35], s97 offen offset:0
    buffer_store_dwordx4 v[164:167], v3, s[32:35], s97 offen offset:1024
D_103:
    s_xor_b32 s57, s40, 0
    s_lshl_b32 s57, s57, 13
    s_add_u32 s57, s57, 131072
    v_add_u32 v4, s57, v3
    s_xor_b32 s57, s40, 2
    s_lshl_b32 s57, s57, 13
    s_add_u32 s57, s57, 131072
    v_add_u32 v5, s57, v3
    s_xor_b32 s57, s40, 3
    s_lshl_b32 s57, s57, 13
    s_add_u32 s57, s57, 131072
    v_add_u32 v6, s57, v3
    s_waitcnt vmcnt(4)
    v_pk_add_f32 v[208:209], v[208:209], v[210:211]
    v_pk_add_f32 v[212:213], v[212:213], v[214:215]
    v_pk_add_f32 v[216:217], v[216:217], v[218:219]
    v_pk_add_f32 v[220:221], v[220:221], v[222:223]
    v_pk_add_f32 v[208:209], v[208:209], v[212:213]
    v_pk_add_f32 v[216:217], v[216:217], v[220:221]
    v_pk_add_f32 v[208:209], v[208:209], v[216:217]
    v_mov_b32 v210, v208
    v_mov_b32 v211, v209
    s_nop 1
    v_permlane32_swap_b32 v208, v210
    v_permlane32_swap_b32 v209, v211
    s_nop 0
    v_pk_add_f32 v[208:209], v[208:209], v[210:211]
    v_mul_f32 v10, 0x3b000000, v208
    v_mul_f32 v209, 0x3b000000, v209
    v_fma_f32 v209, -v10, v10, v209
    v_max_f32 v209, 0, v209
    v_add_f32 v209, 0x3727c5ac, v209
    v_rsq_f32 v8, v209
    s_nop 0
    v_mov_b32 v9, v8
    s_branch P3D_90
P3I_89:
    s_waitcnt vmcnt(0)
    s_lshl_b32 s57, s43, 8
    s_lshl_b32 s58, s44, 4
    s_add_u32 s57, s57, s58
    s_lshl_b32 s58, s40, 2
    s_add_u32 s57, s57, s58
    s_add_u32 s57, s57, 217088
    v_mov_b32 v4, s57
    v_mov_b32 v5, s45
    s_cmp_eq_u32 s46, 1
    s_cbranch_scc1 F_104
    s_mov_b64 exec, 1
    buffer_store_dword v5, v4, s[32:35], 0 offen sc1
    s_mov_b64 exec, -1
    s_branch D_105
F_104:
    s_mov_b64 exec, 1
    buffer_store_dword v5, v4, s[32:35], 0 offen
    s_mov_b64 exec, -1
D_105:
    s_lshl_b32 s57, s43, 8
    s_add_u32 s57, s57, 217088
    v_lshlrev_b32 v4, 2, v0
    v_add_u32 v4, s57, v4
    s_mov_b32 s52, 400000
P_106:
    buffer_load_dword v5, v4, s[32:35], 0 offen sc1
    s_waitcnt vmcnt(0)
    v_and_b32 v6, 0xfffffff0, v5
    v_cmp_eq_u32 vcc, s45, v6
    s_cmp_eq_u64 vcc, -1
    s_cbranch_scc1 PD_107
    s_sub_u32 s52, s52, 1
    s_cmp_eq_u32 s52, 0
    s_cbranch_scc0 P_106
    v_mov_b32 v6, 8
    v_mov_b32 v7, 32
    buffer_store_dword v6, v7, s[36:39], 0 offen
PD_107:
    s_lshr_b32 s57, s40, 1
    s_xor_b32 s57, s57, 0
    s_cmp_eq_u32 s57, 0
    s_cselect_b32 s57, s48, s49
    s_mul_i32 s57, s57, 114688
    s_mul_i32 s58, s40, 28672
    s_add_u32 s57, s57, s58
    s_add_u32 s60, s57, 16777216
    s_add_u32 s60, s60, s68
    s_lshr_b32 s57, s40, 1
    s_xor_b32 s57, s57, 1
    s_cmp_eq_u32 s57, 0
    s_cselect_b32 s57, s48, s49
    s_mul_i32 s57, s57, 114688
    s_mul_i32 s58, s40, 28672
    s_add_u32 s57, s57, s58
    s_add_u32 s61, s57, 16777216
    s_add_u32 s61, s61, s68
    buffer_load_dwordx4 v[176:179], v3, s[32:35], s61 offen offset:0 sc1
    buffer_load_dwordx4 v[180:183], v3, s[32:35], s61 offen offset:1024 sc1
    buffer_load_dwordx4 v[184:187], v3, s[32:35], s61 offen offset:2048 sc1
    buffer_load_dwordx4 v[188:191], v3, s[32:35], s61 offen offset:3072 sc1
    s_add_u32 s61, s61, 4096
    buffer_load_dwordx4 v[192:195], v3, s[32:35], s61 offen offset:0 sc1
    buffer_load_dwordx4 v[196:199], v3, s[32:35], s61 offen offset:1024 sc1
    buffer_load_dwordx4 v[200:203], v3, s[32:35], s61 offen offset:2048 sc1
    buffer_load_dwordx4 v[204:207], v3, s[32:35], s61 offen offset:3072 sc1
    s_lshl_b32 s57, s50, 12
    s_add_u32 s57, s57, 3670016
    v_lshlrev_b32 v14, 4, v1
    v_lshl_add_u32 v14, v2, 11, v14
    buffer_load_dwordx4 v[208:211], v14, s[32:35], s57 offen offset:0
    buffer_load_dwordx4 v[212:215], v14, s[32:35], s57 offen offset:512
    buffer_load_dwordx4 v[216:219], v14, s[32:35], s57 offen offset:1024
    buffer_load_dwordx4 v[220:223], v14, s[32:35], s57 offen offset:1536
    s_xor_b32 s57, s40, 0
    s_lshl_b32 s57, s57, 13
    s_add_u32 s57, s57, 131072
    v_add_u32 v4, s57, v3
    s_xor_b32 s57, s40, 2
    s_lshl_b32 s57, s57, 13
    s_add_u32 s57, s57, 131072
    v_add_u32 v5, s57, v3
    s_xor_b32 s57, s40, 3
    s_lshl_b32 s57, s57, 13
    s_add_u32 s57, s57, 131072
    v_add_u32 v6, s57, v3
    s_waitcnt vmcnt(0)
    v_pk_add_f32 v[208:209], v[208:209], v[210:211]
    v_pk_add_f32 v[212:213], v[212:213], v[214:215]
    v_pk_add_f32 v[216:217], v[216:217], v[218:219]
    v_pk_add_f32 v[220:221], v[220:221], v[222:223]
    v_pk_add_f32 v[208:209], v[208:209], v[212:213]
    v_pk_add_f32 v[216:217], v[216:217], v[220:221]
    v_pk_add_f32 v[208:209], v[208:209], v[216:217]
    v_mov_b32 v210, v208
    v_mov_b32 v211, v209
    s_nop 1
    v_permlane32_swap_b32 v208, v210
    v_permlane32_swap_b32 v209, v211
    s_nop 0
    v_pk_add_f32 v[208:209], v[208:209], v[210:211]
    v_mul_f32 v10, 0x3b000000, v208
    v_mul_f32 v209, 0x3b000000, v209
    v_fma_f32 v209, -v10, v10, v209
    v_max_f32 v209, 0, v209
    v_add_f32 v209, 0x3727c5ac, v209
    v_rsq_f32 v8, v209
    s_nop 0
    v_mov_b32 v9, v8
P3D_90:
    v_mfma_f32_32x32x16_bf16 v[144:159], a[0:3], v[176:179], 0
    v_mfma_f32_32x32x16_bf16 v[160:175], a[4:7], v[176:179], 0
    s_add_u32 s61, s61, 4096
    buffer_load_dwordx4 v[176:179], v3, s[32:35], s61 offen offset:0 sc1
    v_mfma_f32_32x32x16_bf16 v[144:159], a[8:11], v[180:183], v[144:159]
    v_mfma_f32_32x32x16_bf16 v[160:175], a[12:15], v[180:183], v[160:175]
    buffer_load_dwordx4 v[180:183], v3, s[32:35], s61 offen offset:1024 sc1
    v_mfma_f32_32x32x16_bf16 v[144:159], a[16:19], v[184:187], v[144:159]
    v_mfma_f32_32x32x16_bf16 v[160:175], a[20:23], v[184:187], v[160:175]
    buffer_load_dwordx4 v[184:187], v3, s[32:35], s61 offen offset:2048 sc1
    v_mfma_f32_32x32x16_bf16 v[144:159], a[24:27], v[188:191], v[144:159]
    v_mfma_f32_32x32x16_bf16 v[160:175], a[28:31], v[188:191], v[160:175]
    buffer_load_dwordx4 v[188:191], v3, s[32:35], s61 offen offset:3072 sc1
    v_mfma_f32_32x32x16_bf16 v[144:159], a[32:35], v[192:195], v[144:159]
    v_mfma_f32_32x32x16_bf16 v[160:175], a[36:39], v[192:195], v[160:175]
    s_add_u32 s61, s61, 4096
    buffer_load_dwordx4 v[192:195], v3, s[32:35], s61 offen offset:0 sc1
    v_mfma_f32_32x32x16_bf16 v[144:159], a[40:43], v[196:199], v[144:159]
    v_mfma_f32_32x32x16_bf16 v[160:175], a[44:47], v[196:199], v[160:175]
    buffer_load_dwordx4 v[196:199], v3, s[32:35], s61 offen offset:1024 sc1
    v_mfma_f32_32x32x16_bf16 v[144:159], a[48:51], v[200:203], v[144:159]
    v_mfma_f32_32x32x16_bf16 v[160:175], a[52:55], v[200:203], v[160:175]
    buffer_load_dwordx4 v[200:203], v3, s[32:35], s60 offen offset:0 sc1
    v_mfma_f32_32x32x16_bf16 v[144:159], a[56:59], v[204:207], v[144:159]
    v_mfma_f32_32x32x16_bf16 v[160:175], a[60:63], v[204:207], v[160:175]
    buffer_load_dwordx4 v[204:207], v3, s[32:35], s60 offen offset:1024 sc1
    s_waitcnt vmcnt(7)
    v_mfma_f32_32x32x16_bf16 v[144:159], a[64:67], v[176:179], v[144:159]
    v_mfma_f32_32x32x16_bf16 v[160:175], a[68:71], v[176:179], v[160:175]
    s_lshl_b32 s57, s43, 8
    s_lshl_b32 s58, s44, 4
    s_add_u32 s57, s57, s58
    s_lshl_b32 s58, s40, 2
    s_add_u32 s57, s57, s58
    s_add_u32 s57, s57, 212992
    v_mov_b32 v12, s57
    v_mov_b32 v13, s45
    s_cmp_eq_u32 s46, 1
    s_cbranch_scc1 F_108
    s_mov_b64 exec, 1
    buffer_store_dword v13, v12, s[32:35], 0 offen sc1
    s_mov_b64 exec, -1
    s_branch D_109
F_108:
    s_mov_b64 exec, 1
    buffer_store_dword v13, v12, s[32:35], 0 offen
    s_mov_b64 exec, -1
D_109:
    buffer_load_dwordx4 v[176:179], v3, s[32:35], s60 offen offset:2048 sc1
    s_waitcnt vmcnt(8)
    v_mfma_f32_32x32x16_bf16 v[144:159], a[72:75], v[180:183], v[144:159]
    v_mfma_f32_32x32x16_bf16 v[160:175], a[76:79], v[180:183], v[160:175]
    buffer_load_dwordx4 v[180:183], v3, s[32:35], s60 offen offset:3072 sc1
    s_waitcnt vmcnt(8)
    v_mfma_f32_32x32x16_bf16 v[144:159], a[80:83], v[184:187], v[144:159]
    v_mfma_f32_32x32x16_bf16 v[160:175], a[84:87], v[184:187], v[160:175]
    s_add_u32 s60, s60, 4096
    buffer_load_dwordx4 v[184:187], v3, s[32:35], s60 offen offset:0 sc1
    s_waitcnt vmcnt(8)
    v_mfma_f32_32x32x16_bf16 v[144:159], a[88:91], v[188:191], v[144:159]
    v_mfma_f32_32x32x16_bf16 v[160:175], a[92:95], v[188:191], v[160:175]
    buffer_load_dwordx4 v[188:191], v3, s[32:35], s60 offen offset:1024 sc1
    s_waitcnt vmcnt(8)
    v_mfma_f32_32x32x16_bf16 v[144:159], a[96:99], v[192:195], v[144:159]
    v_mfma_f32_32x32x16_bf16 v[160:175], a[100:103], v[192:195], v[160:175]
    buffer_load_dwordx4 v[192:195], v3, s[32:35], s60 offen offset:2048 sc1
    s_waitcnt vmcnt(8)
    v_mfma_f32_32x32x16_bf16 v[144:159], a[104:107], v[196:199], v[144:159]
    v_mfma_f32_32x32x16_bf16 v[160:175], a[108:111], v[196:199], v[160:175]
    buffer_load_dwordx4 v[196:199], v3, s[32:35], s60 offen offset:3072 sc1
    s_waitcnt vmcnt(8)
    v_mfma_f32_32x32x16_bf16 v[112:127], a[0:3], v[200:203], 0
    v_mfma_f32_32x32x16_bf16 v[128:143], a[4:7], v[200:203], 0
    s_add_u32 s60, s60, 4096
    buffer_load_dwordx4 v[200:203], v3, s[32:35], s60 offen offset:0 sc1
    s_waitcnt vmcnt(8)
    v_mfma_f32_32x32x16_bf16 v[112:127], a[8:11], v[204:207], v[112:127]
    v_mfma_f32_32x32x16_bf16 v[128:143], a[12:15], v[204:207], v[128:143]
    s_lshl_b32 s57, s43, 8
    s_add_u32 s57, s57, 212992
    v_lshlrev_b32 v12, 2, v0
    v_add_u32 v12, s57, v12
    buffer_load_dword v13, v12, s[32:35], 0 offen sc1
    buffer_load_dwordx4 v[204:207], v3, s[32:35], s60 offen offset:1024 sc1
    s_waitcnt vmcnt(8)
    v_mfma_f32_32x32x16_bf16 v[112:127], a[16:19], v[176:179], v[112:127]
    v_mfma_f32_32x32x16_bf16 v[128:143], a[20:23], v[176:179], v[128:143]
    buffer_load_dwordx4 v[176:179], v3, s[32:35], s60 offen offset:2048 sc1
    s_waitcnt vmcnt(8)
    v_mfma_f32_32x32x16_bf16 v[112:127], a[24:27], v[180:183], v[112:127]
    v_mfma_f32_32x32x16_bf16 v[128:143], a[28:31], v[180:183], v[128:143]
    buffer_load_dwordx4 v[180:183], v3, s[32:35], s60 offen offset:3072 sc1
    s_waitcnt vmcnt(8)
    v_mfma_f32_32x32x16_bf16 v[112:127], a[32:35], v[184:187], v[112:127]
    v_mfma_f32_32x32x16_bf16 v[128:143], a[36:39], v[184:187], v[128:143]
    s_add_u32 s60, s60, 4096
    buffer_load_dwordx4 v[184:187], v3, s[32:35], s60 offen offset:0 sc1
    s_waitcnt vmcnt(8)
    v_mfma_f32_32x32x16_bf16 v[112:127], a[40:43], v[188:191], v[112:127]
    v_mfma_f32_32x32x16_bf16 v[128:143], a[44:47], v[188:191], v[128:143]
    buffer_load_dwordx4 v[188:191], v3, s[32:35], s60 offen offset:1024 sc1
    s_waitcnt vmcnt(8)
    v_mfma_f32_32x32x16_bf16 v[112:127], a[48:51], v[192:195], v[112:127]
    v_mfma_f32_32x32x16_bf16 v[128:143], a[52:55], v[192:195], v[128:143]
    s_waitcnt vmcnt(5)
    v_and_b32 v14, 0xfffffff0, v13
    v_cmp_eq_u32 vcc, s45, v14
    s_cmp_eq_u64 vcc, -1
    s_cbranch_scc1 FC_110
    s_mov_b32 s52, 400000
P_111:
    buffer_load_dword v13, v12, s[32:35], 0 offen sc1
    s_waitcnt vmcnt(0)
    v_and_b32 v14, 0xfffffff0, v13
    v_cmp_eq_u32 vcc, s45, v14
    s_cmp_eq_u64 vcc, -1
    s_cbranch_scc1 PD_112
    s_sub_u32 s52, s52, 1
    s_cmp_eq_u32 s52, 0
    s_cbranch_scc0 P_111
    v_mov_b32 v14, 7
    v_mov_b32 v15, 28
    buffer_store_dword v14, v15, s[36:39], 0 offen
PD_112:
FC_110:
    buffer_load_dwordx4 v[192:195], v3, s[32:35], s61 offen offset:2048 sc1
    s_waitcnt vmcnt(8)
    v_mfma_f32_32x32x16_bf16 v[112:127], a[56:59], v[196:199], v[112:127]
    v_mfma_f32_32x32x16_bf16 v[128:143], a[60:63], v[196:199], v[128:143]
    buffer_load_dwordx4 v[196:199], v3, s[32:35], s61 offen offset:3072 sc1
    s_waitcnt vmcnt(8)
    v_mfma_f32_32x32x16_bf16 v[112:127], a[64:67], v[200:203], v[112:127]
    v_mfma_f32_32x32x16_bf16 v[128:143], a[68:71], v[200:203], v[128:143]
    s_add_u32 s61, s61, 4096
    buffer_load_dwordx4 v[200:203], v3, s[32:35], s61 offen offset:0 sc1
    s_waitcnt vmcnt(7)
    v_mfma_f32_32x32x16_bf16 v[112:127], a[72:75], v[204:207], v[112:127]
    v_mfma_f32_32x32x16_bf16 v[128:143], a[76:79], v[204:207], v[128:143]
    buffer_load_dwordx4 v[204:207], v3, s[32:35], s61 offen offset:1024 sc1
    s_waitcnt vmcnt(7)
    v_mfma_f32_32x32x16_bf16 v[112:127], a[80:83], v[176:179], v[112:127]
    v_mfma_f32_32x32x16_bf16 v[128:143], a[84:87], v[176:179], v[128:143]
    buffer_load_dwordx4 v[176:179], v3, s[32:35], s61 offen offset:2048 sc1
    s_waitcnt vmcnt(7)
    v_mfma_f32_32x32x16_bf16 v[112:127], a[88:91], v[180:183], v[112:127]
    v_mfma_f32_32x32x16_bf16 v[128:143], a[92:95], v[180:183], v[128:143]
    buffer_load_dwordx4 v[180:183], v3, s[32:35], s61 offen offset:3072 sc1
    s_waitcnt vmcnt(7)
    v_mfma_f32_32x32x16_bf16 v[112:127], a[96:99], v[184:187], v[112:127]
    v_mfma_f32_32x32x16_bf16 v[128:143], a[100:103], v[184:187], v[128:143]
    s_add_u32 s61, s61, 4096
    buffer_load_dwordx4 v[184:187], v3, s[32:35], s61 offen offset:0 sc1
    s_waitcnt vmcnt(7)
    v_mfma_f32_32x32x16_bf16 v[112:127], a[104:107], v[188:191], v[112:127]
    v_mfma_f32_32x32x16_bf16 v[128:143], a[108:111], v[188:191], v[128:143]
    buffer_load_dwordx4 v[188:191], v3, s[32:35], s61 offen offset:1024 sc1
    s_waitcnt vmcnt(7)
    v_mfma_f32_32x32x16_bf16 v[144:159], a[112:115], v[192:195], v[144:159]
    v_mfma_f32_32x32x16_bf16 v[160:175], a[116:119], v[192:195], v[160:175]
    buffer_load_dwordx4 v[192:195], v3, s[32:35], s61 offen offset:2048 sc1
    s_waitcnt vmcnt(7)
    v_mfma_f32_32x32x16_bf16 v[144:159], a[120:123], v[196:199], v[144:159]
    v_mfma_f32_32x32x16_bf16 v[160:175], a[124:127], v[196:199], v[160:175]
    buffer_load_dwordx4 v[196:199], v3, s[32:35], s61 offen offset:3072 sc1
    s_waitcnt vmcnt(7)
    v_mfma_f32_32x32x16_bf16 v[144:159], a[128:131], v[200:203], v[144:159]
    v_mfma_f32_32x32x16_bf16 v[160:175], a[132:135], v[200:203], v[160:175]
    s_add_u32 s61, s61, 4096
    buffer_load_dwordx4 v[200:203], v3, s[32:35], s61 offen offset:0 sc1
    s_waitcnt vmcnt(7)
    v_mfma_f32_32x32x16_bf16 v[144:159], a[136:139], v[204:207], v[144:159]
    v_mfma_f32_32x32x16_bf16 v[160:175], a[140:143], v[204:207], v[160:175]
    buffer_load_dwordx4 v[204:207], v3, s[32:35], s61 offen offset:1024 sc1
    s_waitcnt vmcnt(7)
    v_mfma_f32_32x32x16_bf16 v[144:159], a[144:147], v[176:179], v[144:159]
    v_mfma_f32_32x32x16_bf16 v[160:175], a[148:151], v[176:179], v[160:175]
    buffer_load_dwordx4 v[176:179], v3, s[32:35], s61 offen offset:2048 sc1
    s_waitcnt vmcnt(7)
    v_mfma_f32_32x32x16_bf16 v[144:159], a[152:155], v[180:183], v[144:159]
    v_mfma_f32_32x32x16_bf16 v[160:175], a[156:159], v[180:183], v[160:175]
    buffer_load_dwordx4 v[180:183], v3, s[32:35], s61 offen offset:3072 sc1
    s_waitcnt vmcnt(7)
    v_mfma_f32_32x32x16_bf16 v[144:159], a[160:163], v[184:187], v[144:159]
    v_mfma_f32_32x32x16_bf16 v[160:175], a[164:167], v[184:187], v[160:175]
    buffer_load_dwordx4 v[184:187], v3, s[32:35], s60 offen offset:2048 sc1
    s_waitcnt vmcnt(7)
    v_mfma_f32_32x32x16_bf16 v[144:159], a[168:171], v[188:191], v[144:159]
    v_mfma_f32_32x32x16_bf16 v[160:175], a[172:175], v[188:191], v[160:175]
    buffer_load_dwordx4 v[188:191], v3, s[32:35], s60 offen offset:3072 sc1
    s_waitcnt vmcnt(7)
    v_mfma_f32_32x32x16_bf16 v[144:159], a[176:179], v[192:195], v[144:159]
    v_mfma_f32_32x32x16_bf16 v[160:175], a[180:183], v[192:195], v[160:175]
    s_add_u32 s60, s60, 4096
    buffer_load_dwordx4 v[192:195], v3, s[32:35], s60 offen offset:0 sc1
    s_waitcnt vmcnt(7)
    v_mfma_f32_32x32x16_bf16 v[144:159], a[184:187], v[196:199], v[144:159]
    v_mfma_f32_32x32x16_bf16 v[160:175], a[188:191], v[196:199], v[160:175]
    buffer_load_dwordx4 v[196:199], v3, s[32:35], s60 offen offset:1024 sc1
    s_waitcnt vmcnt(7)
    v_mfma_f32_32x32x16_bf16 v[144:159], a[192:195], v[200:203], v[144:159]
    v_mfma_f32_32x32x16_bf16 v[160:175], a[196:199], v[200:203], v[160:175]
    buffer_load_dwordx4 v[200:203], v3, s[32:35], s60 offen offset:2048 sc1
    s_waitcnt vmcnt(7)
    v_mfma_f32_32x32x16_bf16 v[144:159], a[200:203], v[204:207], v[144:159]
    v_mfma_f32_32x32x16_bf16 v[160:175], a[204:207], v[204:207], v[160:175]
    buffer_load_dwordx4 v[204:207], v3, s[32:35], s60 offen offset:3072 sc1
    s_waitcnt vmcnt(7)
    v_mfma_f32_32x32x16_bf16 v[144:159], a[208:211], v[176:179], v[144:159]
    v_mfma_f32_32x32x16_bf16 v[160:175], a[212:215], v[176:179], v[160:175]
    s_add_u32 s60, s60, 4096
    buffer_load_dwordx4 v[176:179], v3, s[32:35], s60 offen offset:0 sc1
    s_waitcnt vmcnt(7)
    v_mfma_f32_32x32x16_bf16 v[144:159], a[216:219], v[180:183], v[144:159]
    v_mfma_f32_32x32x16_bf16 v[160:175], a[220:223], v[180:183], v[160:175]
    buffer_load_dwordx4 v[180:183], v3, s[32:35], s60 offen offset:1024 sc1
    s_waitcnt vmcnt(7)
    v_mfma_f32_32x32x16_bf16 v[112:127], a[112:115], v[184:187], v[112:127]
    v_mfma_f32_32x32x16_bf16 v[128:143], a[116:119], v[184:187], v[128:143]
    buffer_load_dwordx4 v[184:187], v3, s[32:35], s60 offen offset:2048 sc1
    s_waitcnt vmcnt(7)
    v_mfma_f32_32x32x16_bf16 v[112:127], a[120:123], v[188:191], v[112:127]
    v_mfma_f32_32x32x16_bf16 v[128:143], a[124:127], v[188:191], v[128:143]
    buffer_load_dwordx4 v[188:191], v3, s[32:35], s60 offen offset:3072 sc1
    s_waitcnt vmcnt(7)
    v_mfma_f32_32x32x16_bf16 v[112:127], a[128:131], v[192:195], v[112:127]
    v_mfma_f32_32x32x16_bf16 v[128:143], a[132:135], v[192:195], v[128:143]
    s_add_u32 s60, s60, 4096
    buffer_load_dwordx4 v[192:195], v3, s[32:35], s60 offen offset:0 sc1
    s_waitcnt vmcnt(7)
    v_mfma_f32_32x32x16_bf16 v[112:127], a[136:139], v[196:199], v[112:127]
    v_mfma_f32_32x32x16_bf16 v[128:143], a[140:143], v[196:199], v[128:143]
    ds_write_b128 v4, v[144:147] offset:0
    ds_write_b128 v4, v[148:151] offset:1024
    buffer_load_dwordx4 v[196:199], v3, s[32:35], s60 offen offset:1024 sc1
    s_waitcnt vmcnt(7)
    v_mfma_f32_32x32x16_bf16 v[112:127], a[144:147], v[200:203], v[112:127]
    v_mfma_f32_32x32x16_bf16 v[128:143], a[148:151], v[200:203], v[128:143]
    ds_write_b128 v4, v[152:155] offset:2048
    ds_write_b128 v4, v[156:159] offset:3072
    buffer_load_dwordx4 v[200:203], v3, s[32:35], s60 offen offset:2048 sc1
    s_waitcnt vmcnt(7)
    v_mfma_f32_32x32x16_bf16 v[112:127], a[152:155], v[204:207], v[112:127]
    v_mfma_f32_32x32x16_bf16 v[128:143], a[156:159], v[204:207], v[128:143]
    ds_write_b128 v4, v[160:163] offset:4096
    ds_write_b128 v4, v[164:167] offset:5120
    buffer_load_dwordx4 v[204:207], v3, s[32:35], s60 offen offset:3072 sc1
    s_waitcnt vmcnt(7)
    v_mfma_f32_32x32x16_bf16 v[112:127], a[160:163], v[176:179], v[112:127]
    v_mfma_f32_32x32x16_bf16 v[128:143], a[164:167], v[176:179], v[128:143]
    ds_write_b128 v4, v[168:171] offset:6144
    ds_write_b128 v4, v[172:175] offset:7168
    s_waitcnt vmcnt(6)
    v_mfma_f32_32x32x16_bf16 v[112:127], a[168:171], v[180:183], v[112:127]
    v_mfma_f32_32x32x16_bf16 v[128:143], a[172:175], v[180:183], v[128:143]
    s_waitcnt vmcnt(5)
    v_mfma_f32_32x32x16_bf16 v[112:127], a[176:179], v[184:187], v[112:127]
    v_mfma_f32_32x32x16_bf16 v[128:143], a[180:183], v[184:187], v[128:143]
    s_waitcnt lgkmcnt(0)
    s_barrier
    s_waitcnt vmcnt(4)
    v_mfma_f32_32x32x16_bf16 v[112:127], a[184:187], v[188:191], v[112:127]
    v_mfma_f32_32x32x16_bf16 v[128:143], a[188:191], v[188:191], v[128:143]
    ds_read_b128 v[240:243], v5 offset:4096
    ds_read_b128 v[244:247], v5 offset:5120
    s_waitcnt vmcnt(3)
    v_mfma_f32_32x32x16_bf16 v[112:127], a[192:195], v[192:195], v[112:127]
    v_mfma_f32_32x32x16_bf16 v[128:143], a[196:199], v[192:195], v[128:143]
    ds_read_b128 v[248:251], v5 offset:6144
    ds_read_b128 v[252:255], v5 offset:7168
    s_waitcnt vmcnt(2)
    v_mfma_f32_32x32x16_bf16 v[112:127], a[200:203], v[196:199], v[112:127]
    v_mfma_f32_32x32x16_bf16 v[128:143], a[204:207], v[196:199], v[128:143]
    ds_read_b128 v[224:227], v5 offset:0
    ds_read_b128 v[228:231], v5 offset:1024
    s_waitcnt vmcnt(1)
    v_mfma_f32_32x32x16_bf16 v[112:127], a[208:211], v[200:203], v[112:127]
    v_mfma_f32_32x32x16_bf16 v[128:143], a[212:215], v[200:203], v[128:143]
    ds_read_b128 v[232:235], v5 offset:2048
    ds_read_b128 v[236:239], v5 offset:3072
    s_waitcnt vmcnt(0)
    v_mfma_f32_32x32x16_bf16 v[112:127], a[216:219], v[204:207], v[112:127]
    v_mfma_f32_32x32x16_bf16 v[128:143], a[220:223], v[204:207], v[128:143]
    v_lshlrev_b32 v176, 16, v16
    v_and_b32 v177, 0xffff0000, v16
    v_lshlrev_b32 v178, 16, v17
    v_and_b32 v179, 0xffff0000, v17
    v_lshlrev_b32 v180, 16, v18
    v_and_b32 v181, 0xffff0000, v18
    v_lshlrev_b32 v182, 16, v19
    v_and_b32 v183, 0xffff0000, v19
    v_lshlrev_b32 v184, 16, v20
    v_and_b32 v185, 0xffff0000, v20
    v_lshlrev_b32 v186, 16, v21
    v_and_b32 v187, 0xffff0000, v21
    v_lshlrev_b32 v188, 16, v22
    v_and_b32 v189, 0xffff0000, v22
    v_lshlrev_b32 v190, 16, v23
    v_and_b32 v191, 0xffff0000, v23
    s_waitcnt lgkmcnt(0)
    v_pk_add_f32 v[128:129], v[128:129], v[240:241]
    v_pk_add_f32 v[130:131], v[130:131], v[242:243]
    v_pk_add_f32 v[132:133], v[132:133], v[244:245]
    v_pk_add_f32 v[134:135], v[134:135], v[246:247]
    v_pk_add_f32 v[136:137], v[136:137], v[248:249]
    v_pk_add_f32 v[138:139], v[138:139], v[250:251]
    v_pk_add_f32 v[140:141], v[140:141], v[252:253]
    v_pk_add_f32 v[142:143], v[142:143], v[254:255]
    ds_write_b128 v5, v[128:131] offset:0
    ds_write_b128 v5, v[132:135] offset:1024
    ds_write_b128 v5, v[136:139] offset:2048
    ds_write_b128 v5, v[140:143] offset:3072
    v_pk_add_f32 v[112:113], v[112:113], v[224:225]
    v_pk_add_f32 v[114:115], v[114:115], v[226:227]
    v_pk_add_f32 v[116:117], v[116:117], v[228:229]
    v_pk_add_f32 v[118:119], v[118:119], v[230:231]
    v_pk_add_f32 v[120:121], v[120:121], v[232:233]
    v_pk_add_f32 v[122:123], v[122:123], v[234:235]
    v_pk_add_f32 v[124:125], v[124:125], v[236:237]
    v_pk_add_f32 v[126:127], v[126:127], v[238:239]
    s_waitcnt lgkmcnt(0)
    s_barrier
    ds_read_b128 v[192:195], v6 offset:0
    ds_read_b128 v[196:199], v6 offset:1024
    ds_read_b128 v[200:203], v6 offset:2048
    ds_read_b128 v[204:207], v6 offset:3072
    s_waitcnt lgkmcnt(3)
    v_pk_add_f32 v[112:113], v[112:113], v[192:193]
    v_pk_add_f32 v[114:115], v[114:115], v[194:195]
    s_waitcnt lgkmcnt(2)
    v_pk_add_f32 v[116:117], v[116:117], v[196:197]
    v_pk_add_f32 v[118:119], v[118:119], v[198:199]
    s_waitcnt lgkmcnt(1)
    v_pk_add_f32 v[120:121], v[120:121], v[200:201]
    v_pk_add_f32 v[122:123], v[122:123], v[202:203]
    s_waitcnt lgkmcnt(0)
    v_pk_add_f32 v[124:125], v[124:125], v[204:205]
    v_pk_add_f32 v[126:127], v[126:127], v[206:207]
    v_pk_fma_f32 v[112:113], v[112:113], v[8:9], v[176:177]
    v_pk_fma_f32 v[114:115], v[114:115], v[8:9], v[178:179]
    v_pk_fma_f32 v[116:117], v[116:117], v[8:9], v[180:181]
    v_pk_fma_f32 v[118:119], v[118:119], v[8:9], v[182:183]
    v_pk_fma_f32 v[120:121], v[120:121], v[8:9], v[184:185]
    v_pk_fma_f32 v[122:123], v[122:123], v[8:9], v[186:187]
    v_pk_fma_f32 v[124:125], v[124:125], v[8:9], v[188:189]
    v_pk_fma_f32 v[126:127], v[126:127], v[8:9], v[190:191]
    v_cvt_pk_bf16_f32 v16, v112, v113
    v_cvt_pk_bf16_f32 v17, v114, v115
    v_cvt_pk_bf16_f32 v18, v116, v117
    v_cvt_pk_bf16_f32 v19, v118, v119
    v_cvt_pk_bf16_f32 v20, v120, v121
    v_cvt_pk_bf16_f32 v21, v122, v123
    v_cvt_pk_bf16_f32 v22, v124, v125
    v_cvt_pk_bf16_f32 v23, v126, v127
    v_lshlrev_b32 v4, 6, v1
    v_add_u32 v4, s50, v4
    v_lshlrev_b32 v4, 10, v4
    s_bitcmp1_b32 s40, 0
    s_cbranch_scc1 OM_113
    s_lshl_b32 s57, s42, 6
    v_lshl_add_u32 v5, v2, 4, v4
    v_add_u32 v5, s57, v5
    v_permlane32_swap_b32 v16, v18
    v_permlane32_swap_b32 v17, v19
    v_permlane32_swap_b32 v20, v22
    v_permlane32_swap_b32 v21, v23
    s_nop 1
    buffer_store_dwordx4 v[16:19], v5, s[28:31], 0 offen offset:0
    buffer_store_dwordx4 v[20:23], v5, s[28:31], 0 offen offset:32
    s_branch OD_114
OM_113:
    s_lshl_b32 s57, s42, 6
    s_sub_u32 s57, 968, s57
    v_lshlrev_b32 v5, 3, v2
    v_sub_u32 v5, s57, v5
    v_add_u32 v5, v5, v4
    v_mov_b32 v176, v16
    v_mov_b32 v177, v18
    v_mov_b32 v178, v18
    v_mov_b32 v179, v20
    v_mov_b32 v180, v20
    v_mov_b32 v181, v22
    v_mov_b32 v182, v22
    v_mov_b32 v183, v22
    v_cmp_gt_u32 vcc, 32, v0
    v_mov_b32 v6, 0xffff
    v_permlane32_swap_b32 v176, v177
    v_permlane32_swap_b32 v178, v179
    v_permlane32_swap_b32 v180, v181
    v_permlane32_swap_b32 v182, v183
    s_nop 1
    v_cndmask_b32 v176, v176, v177, vcc
    v_bfi_b32 v192, v6, v176, v17
    v_bfi_b32 v193, v6, v17, v16
    v_cndmask_b32 v178, v178, v179, vcc
    v_bfi_b32 v194, v6, v178, v19
    v_bfi_b32 v195, v6, v19, v18
    v_cndmask_b32 v180, v180, v181, vcc
    v_bfi_b32 v196, v6, v180, v21
    v_bfi_b32 v197, v6, v21, v20
    v_cndmask_b32 v182, v182, v183, vcc
    v_bfi_b32 v198, v6, v182, v23
    v_bfi_b32 v199, v6, v23, v22
    buffer_store_dwordx2 v[192:193], v5, s[28:31], 0 offen offset:48
    buffer_store_dwordx2 v[194:195], v5, s[28:31], 0 offen offset:32
    buffer_store_dwordx2 v[196:197], v5, s[28:31], 0 offen offset:16
    s_lshl_b32 s57, s42, 6
    s_sub_u32 s57, 1024, s57
    s_cmp_eq_u32 s42, 0
    s_cselect_b32 s57, 512, s57
    v_add_u32 v7, s57, v4
    s_mov_b32 exec_hi, 0
    buffer_store_dwordx2 v[198:199], v5, s[28:31], 0 offen
    buffer_store_short v16, v7, s[28:31], 0 offen
    s_mov_b32 exec_hi, -1
    s_mov_b32 exec_lo, 0
    buffer_store_short_d16_hi v198, v5, s[28:31], 0 offen offset:2
    buffer_store_dword v199, v5, s[28:31], 0 offen offset:4
    s_mov_b32 exec_lo, -1
OD_114:
L_FIN:
    s_waitcnt vmcnt(0)
    s_cmp_eq_u32 s2, 0
    s_cbranch_scc0 NE_115
    s_cmp_eq_u32 s40, 0
    s_cbranch_scc0 NE_115
    v_mov_b32 v4, 0
    v_mov_b32 v5, s45
    s_mov_b64 exec, 1
    buffer_store_dword v5, v4, s[32:35], 0 offen sc1
    s_mov_b64 exec, -1
NE_115:
L_END:
    s_endpgm
.section .rodata,"a"
.p2align 6
.amdhsa_kernel interleave_layers__spectral_fnet__dense_activation_relu__prompt_kernel
  .amdhsa_next_free_vgpr 512
  .amdhsa_next_free_sgpr 102
  .amdhsa_accum_offset 256
  .amdhsa_group_segment_fixed_size 0
  .amdhsa_kernarg_size 88
  .amdhsa_user_sgpr_count 2
  .amdhsa_user_sgpr_kernarg_segment_ptr 1
  .amdhsa_system_sgpr_workgroup_id_x 1
.end_amdhsa_kernel
```
